```python
import torch

def _softmax(x, axis=-1):
    return torch.softmax(x, dim=axis)

def _gelu(x):
    return torch.nn.functional.gelu(x, approximate='tanh')

def _silu(x):
    return torch.nn.functional.silu(x)

def _sigmoid(x):
    return torch.sigmoid(x)

def _layernorm(x, axis=-1, eps=1e-05):
    m = x.mean(dim=axis, keepdim=True)
    v = x.var(dim=axis, keepdim=True, unbiased=False)
    return (x - m) / torch.sqrt(v + eps)

def _scatter_add(tgt, idx, src, axis=0):
    return tgt.clone().index_add_(axis, idx, src)

def _segment_sum(src, seg, n):
    out = torch.zeros((n,) + src.shape[1:], dtype=src.dtype)
    return out.index_add_(0, seg, src)

def _pad(x, pw):
    flat = tuple((v for pair in reversed(pw) for v in pair))
    return torch.nn.functional.pad(x, flat)
kernel_name = 'standalone__tensor_product_equiv_equiformer__graph'

def setup_inputs():

    _w = lambda a: (lambda t: t.to(torch.bfloat16) if t.is_floating_point() else t)(torch.as_tensor(a))
    N, deg, C, De = (25000, 32, 64, max(0, 1))
    E = N * deg
    src = (lambda lo, hi, *s: torch.randint(lo, hi, s))(0, N, E).to(torch.int64)
    dst = (lambda lo, hi, *s: torch.randint(lo, hi, s))(0, N, E).to(torch.int64)
    rvec = (lambda *s: torch.randn(*s, dtype=torch.bfloat16) * 0.05)(E, 3).to(float)
    rn = (torch.linalg.norm(rvec, dim=-1, keepdim=True) + 1e-06).to(float)
    rhat = (rvec / rn).to(float)
    eps = torch.zeros((3, 3, 3), dtype=float)
    eps[0, 1, 2] = eps[1, 2, 0] = eps[2, 0, 1] = 1.0
    eps[0, 2, 1] = eps[2, 1, 0] = eps[1, 0, 2] = -1.0
    return {'x': _w((lambda *s: torch.randn(*s, dtype=torch.bfloat16) * 0.4)(N, 4 * C).to(float)), 'rhat': _w(rhat), 'e_attr': _w((lambda *s: torch.randn(*s, dtype=torch.bfloat16) * 0.4)(E, De).to(float)), 'src': _w(src), 'dst': _w(dst), 'w_rad': _w((lambda *s: torch.randn(*s, dtype=torch.bfloat16) * 0.4)(De, 5 * C).to(float)), 'w_si0': _w((lambda *s: torch.randn(*s, dtype=torch.bfloat16) * 0.4)(2 * C, C).to(float)), 'w_si1': _w((lambda *s: torch.randn(*s, dtype=torch.bfloat16) * 0.05)(3 * C, C).to(float)), 'cg_eps': _w(eps)}

def reference(x, rhat, e_attr, src, dst, w_rad, w_si0, w_si1, cg_eps):
    N = x.shape[0]
    C = w_si0.shape[1]
    E = rhat.shape[0]
    x0 = x[:, :C].clone()
    x1 = x[:, C:].reshape(N, 3, C)
    R = (e_attr @ w_rad).reshape(E, 5, C)
    f0 = x0[src]
    f1 = x1[src]
    Y1 = rhat
    p00_0 = f0 * R[:, 0, :]
    p11_0 = torch.einsum('ejc,ej->ec', f1, Y1) * R[:, 1, :]
    p01_1 = torch.einsum('ec,ej->ejc', f0, Y1) * R[:, 2, :][:, None, :]
    p10_1 = f1 * R[:, 3, :][:, None, :]
    p11_1 = torch.einsum('ijk,ekc,ej->eic', cg_eps, f1, Y1) * R[:, 4, :][:, None, :]
    m0 = torch.concatenate([p00_0, p11_0], axis=-1) @ w_si0
    m1 = torch.einsum('ejp,pc->ejc', torch.concatenate([p01_1, p10_1, p11_1], axis=-1), w_si1)
    agg0 = _segment_sum(m0, dst, N)
    agg1 = _segment_sum(m1.reshape(E, 3 * C), dst, N).reshape(N, 3, C)
    gate = _sigmoid(agg0)
    out1 = agg1 * gate[:, None, :]
    return torch.concatenate([agg0, out1.reshape(N, 3 * C)], axis=-1)
```

```asm
; @launch grid=(256,1,1) block=(1024,1,1) lds=143424
.amdgcn_target "amdgcn-amd-amdhsa--gfx950"
.text
    .globl standalone__tensor_product_equiv_equiformer__graph_kernel
    .p2align 8
    .type standalone__tensor_product_equiv_equiformer__graph_kernel,@function
standalone__tensor_product_equiv_equiformer__graph_kernel:
    s_cmp_ge_u32 s2, 256
    s_cbranch_scc1 K2_END
    s_load_dwordx2 s[56:57], s[0:1], 0x58
    s_load_dwordx2 s[58:59], s[0:1], 0x0
    s_load_dwordx2 s[60:61], s[0:1], 0x48
    s_load_dwordx2 s[64:65], s[0:1], 0x28
    s_load_dwordx2 s[66:67], s[0:1], 0x30
    s_load_dwordx2 s[68:69], s[0:1], 0x38
    s_load_dwordx8 s[8:15], s[0:1], 0x0
    s_load_dwordx2 s[16:17], s[0:1], 0x20
    s_load_dwordx2 s[26:27], s[0:1], 0x58
    s_load_dwordx2 s[38:39], s[0:1], 0x50
    v_readfirstlane_b32 s6, v0
    v_lshlrev_b32 v1, 2, v0
    v_mov_b32 v2, 0
    s_cmp_ge_u32 s2, 250
    s_cbranch_scc1 K1_IDLE
    ds_write_b32 v1, v2
    s_cmp_ge_u32 s6, 832
    s_cbranch_scc1 K1_AUX
    s_mul_i32 s3, s2, 12800
    v_lshlrev_b32 v3, 4, v0
    v_add_u32 v3, s3, v3
    v_lshrrev_b32 v4, 1, v3
    v_add_u32 v5, v3, v4
    v_cmp_gt_u32 vcc, 800, v0
    s_waitcnt lgkmcnt(0)
    s_and_saveexec_b64 s[28:29], vcc
    s_mov_b64 s[30:31], exec
    global_load_dwordx4 v[8:11], v3, s[16:17] nt
    s_barrier
    global_load_dwordx4 v[12:15], v3, s[14:15] nt
    global_load_dwordx2 v[16:17], v4, s[12:13] nt
    global_load_dwordx4 v[18:21], v5, s[10:11] nt
    global_load_dwordx2 v[22:23], v5, s[10:11] offset:16 nt
    s_mov_b32 s4, 42800
    v_mov_b32 v60, 1
    s_waitcnt vmcnt(4)
    v_mul_u32_u24 v24, s4, v8
    v_lshrrev_b32 v24, 22, v24
    v_lshlrev_b32 v28, 2, v24
    ds_add_rtn_u32 v32, v28, v60
    v_mul_u32_u24 v25, s4, v9
    v_lshrrev_b32 v25, 22, v25
    v_lshlrev_b32 v29, 2, v25
    ds_add_rtn_u32 v33, v29, v60
    v_mul_u32_u24 v26, s4, v10
    v_lshrrev_b32 v26, 22, v26
    v_lshlrev_b32 v30, 2, v26
    ds_add_rtn_u32 v34, v30, v60
    v_mul_u32_u24 v27, s4, v11
    v_lshrrev_b32 v27, 22, v27
    v_lshlrev_b32 v31, 2, v27
    ds_add_rtn_u32 v35, v31, v60
    v_mul_u32_u24 v36, 98, v24
    v_sub_u32 v36, v8, v36
    v_lshrrev_b32 v40, 3, v36
    v_and_b32 v44, 7, v36
    v_lshlrev_b32 v44, 18, v44
    v_lshl_or_b32 v44, v40, 28, v44
    v_mul_u32_u24 v37, 98, v25
    v_sub_u32 v37, v9, v37
    v_lshrrev_b32 v41, 3, v37
    v_and_b32 v45, 7, v37
    v_lshlrev_b32 v45, 18, v45
    v_lshl_or_b32 v45, v41, 28, v45
    v_mul_u32_u24 v38, 98, v26
    v_sub_u32 v38, v10, v38
    v_lshrrev_b32 v42, 3, v38
    v_and_b32 v46, 7, v38
    v_lshlrev_b32 v46, 18, v46
    v_lshl_or_b32 v46, v42, 28, v46
    v_mul_u32_u24 v39, 98, v27
    v_sub_u32 v39, v11, v39
    v_lshrrev_b32 v43, 3, v39
    v_and_b32 v47, 7, v39
    v_lshlrev_b32 v47, 18, v47
    v_lshl_or_b32 v47, v43, 28, v47
    s_mov_b64 exec, -1
    v_and_b32 v1, 63, v0
    v_lshlrev_b32 v1, 4, v1
    s_waitcnt lgkmcnt(0)
    s_barrier
    ds_read_b128 v[8:11], v1 offset:0
    s_waitcnt lgkmcnt(0)
    v_add_u32 v48, v8, v9
    v_add_u32 v49, v48, v10
    v_add_u32 v50, v49, v11
    v_mov_b32 v51, v50
    s_nop 1
    v_add_u32_dpp v51, v51, v51 row_shr:1 row_mask:0xf bank_mask:0xf bound_ctrl:0
    s_nop 1
    v_add_u32_dpp v51, v51, v51 row_shr:2 row_mask:0xf bank_mask:0xf bound_ctrl:0
    s_nop 1
    v_add_u32_dpp v51, v51, v51 row_shr:4 row_mask:0xf bank_mask:0xf bound_ctrl:0
    s_nop 1
    v_add_u32_dpp v51, v51, v51 row_shr:8 row_mask:0xf bank_mask:0xf bound_ctrl:0
    s_nop 1
    v_add_u32_dpp v51, v51, v51 row_bcast:15 row_mask:0xa bank_mask:0xf
    s_nop 1
    v_add_u32_dpp v51, v51, v51 row_bcast:31 row_mask:0xc bank_mask:0xf
    v_sub_u32 v52, v51, v50
    v_add_u32 v53, v52, v8
    v_add_u32 v54, v52, v48
    v_add_u32 v55, v52, v49
    ds_write_b128 v1, v[52:55] offset:1024
    s_mov_b64 exec, s[30:31]
    ds_read_b32 v24, v28 offset:1024
    ds_read_b32 v25, v29 offset:1024
    ds_read_b32 v26, v30 offset:1024
    ds_read_b32 v27, v31 offset:1024
    s_waitcnt lgkmcnt(3)
    v_add_u32 v24, v24, v32
    v_mul_u32_u24 v24, 12, v24
    v_add_u32 v24, 4096, v24
    s_waitcnt lgkmcnt(2)
    v_add_u32 v25, v25, v33
    v_mul_u32_u24 v25, 12, v25
    v_add_u32 v25, 4096, v25
    s_waitcnt lgkmcnt(1)
    v_add_u32 v26, v26, v34
    v_mul_u32_u24 v26, 12, v26
    v_add_u32 v26, 4096, v26
    s_waitcnt lgkmcnt(0)
    v_add_u32 v27, v27, v35
    v_mul_u32_u24 v27, 12, v27
    v_add_u32 v27, 4096, v27
    s_waitcnt vmcnt(3)
    v_mul_u32_u24 v36, 41, v12
    v_lshrrev_b32 v36, 16, v36
    v_lshl_or_b32 v36, v36, 24, v12
    v_or_b32 v36, v44, v36
    ds_write_b32 v24, v36 offset:8
    v_mul_u32_u24 v37, 41, v13
    v_lshrrev_b32 v37, 16, v37
    v_lshl_or_b32 v37, v37, 24, v13
    v_or_b32 v37, v45, v37
    ds_write_b32 v25, v37 offset:8
    v_mul_u32_u24 v38, 41, v14
    v_lshrrev_b32 v38, 16, v38
    v_lshl_or_b32 v38, v38, 24, v14
    v_or_b32 v38, v46, v38
    ds_write_b32 v26, v38 offset:8
    v_mul_u32_u24 v39, 41, v15
    v_lshrrev_b32 v39, 16, v39
    v_lshl_or_b32 v39, v39, 24, v15
    v_or_b32 v39, v47, v39
    ds_write_b32 v27, v39 offset:8
    s_waitcnt vmcnt(0)
    s_mov_b32 s7, 0xffff0000
    v_lshlrev_b32 v40, 16, v16
    v_and_b32 v41, s7, v16
    v_lshlrev_b32 v42, 16, v17
    v_and_b32 v43, s7, v17
    v_lshlrev_b32 v44, 16, v18
    v_mul_f32 v44, v40, v44
    v_and_b32 v45, s7, v18
    v_mul_f32 v45, v40, v45
    v_lshlrev_b32 v46, 16, v19
    v_mul_f32 v46, v40, v46
    v_cvt_pk_bf16_f32 v48, v40, v44
    v_cvt_pk_bf16_f32 v49, v45, v46
    ds_write2_b32 v24, v48, v49 offset1:1
    v_and_b32 v44, s7, v19
    v_mul_f32 v44, v41, v44
    v_lshlrev_b32 v45, 16, v20
    v_mul_f32 v45, v41, v45
    v_and_b32 v46, s7, v20
    v_mul_f32 v46, v41, v46
    v_cvt_pk_bf16_f32 v50, v41, v44
    v_cvt_pk_bf16_f32 v51, v45, v46
    ds_write2_b32 v25, v50, v51 offset1:1
    v_lshlrev_b32 v44, 16, v21
    v_mul_f32 v44, v42, v44
    v_and_b32 v45, s7, v21
    v_mul_f32 v45, v42, v45
    v_lshlrev_b32 v46, 16, v22
    v_mul_f32 v46, v42, v46
    v_cvt_pk_bf16_f32 v52, v42, v44
    v_cvt_pk_bf16_f32 v53, v45, v46
    ds_write2_b32 v26, v52, v53 offset1:1
    v_and_b32 v44, s7, v22
    v_mul_f32 v44, v43, v44
    v_lshlrev_b32 v45, 16, v23
    v_mul_f32 v45, v43, v45
    v_and_b32 v46, s7, v23
    v_mul_f32 v46, v43, v46
    v_cvt_pk_bf16_f32 v54, v43, v44
    v_cvt_pk_bf16_f32 v55, v45, v46
    ds_write2_b32 v27, v54, v55 offset1:1
    s_mov_b64 exec, -1
    s_branch K1_JOIN
K1_AUX:
    v_and_b32 v1, 63, v0
    v_lshlrev_b32 v1, 4, v1
    s_waitcnt lgkmcnt(0)
    s_cmp_lg_u32 s6, 960
    s_cbranch_scc1 K1_AUX1
    s_cmp_lg_u32 s2, 0
    s_cbranch_scc1 K1_AUX1
    s_memrealtime s[36:37]
    s_waitcnt lgkmcnt(0)
    s_or_b32 s36, s36, 1
    v_mov_b32 v63, s36
    s_mov_b64 exec, 1
    global_store_dword v2, v63, s[38:39] sc1
    s_mov_b64 exec, -1
K1_AUX1:
    s_barrier
    s_barrier
    s_cmp_lg_u32 s6, 960
    s_cbranch_scc1 K1_AUX2
    s_mov_b32 s36, 0
    v_mov_b32 v62, 0
    global_load_dword v63, v62, s[38:39]
    s_branch K1_TP_W
K1_TP_L:
    global_load_dword v63, v62, s[38:39] sc1
K1_TP_W:
    s_waitcnt vmcnt(0)
    v_readfirstlane_b32 s37, v63
    s_add_u32 s36, s36, 1
    s_cmp_gt_u32 s36, 400000
    s_cbranch_scc1 K2_END
    s_cmp_lg_u32 s37, 0
    s_cbranch_scc1 K1_TP_D
    s_sleep 1
    s_branch K1_TP_L
K1_TP_D:
    v_mov_b32 v62, 143376
    ds_write_b32 v62, v63
    s_branch K1_JOIN
K1_AUX2:
    s_cmp_lg_u32 s6, 832
    s_cbranch_scc1 K1_JOIN
    ds_read_b128 v[8:11], v1 offset:0
    s_waitcnt lgkmcnt(0)
    v_add_u32 v48, v8, v9
    v_add_u32 v49, v48, v10
    v_add_u32 v50, v49, v11
    v_mov_b32 v51, v50
    s_nop 1
    v_add_u32_dpp v51, v51, v51 row_shr:1 row_mask:0xf bank_mask:0xf bound_ctrl:0
    s_nop 1
    v_add_u32_dpp v51, v51, v51 row_shr:2 row_mask:0xf bank_mask:0xf bound_ctrl:0
    s_nop 1
    v_add_u32_dpp v51, v51, v51 row_shr:4 row_mask:0xf bank_mask:0xf bound_ctrl:0
    s_nop 1
    v_add_u32_dpp v51, v51, v51 row_shr:8 row_mask:0xf bank_mask:0xf bound_ctrl:0
    s_nop 1
    v_add_u32_dpp v51, v51, v51 row_bcast:15 row_mask:0xa bank_mask:0xf
    s_nop 1
    v_add_u32_dpp v51, v51, v51 row_bcast:31 row_mask:0xc bank_mask:0xf
    v_sub_u32 v52, v51, v50
    v_add_u32 v53, v52, v8
    v_add_u32 v54, v52, v48
    v_add_u32 v55, v52, v49
    v_lshl_or_b32 v56, v8, 12, v52
    v_lshl_or_b32 v57, v9, 12, v53
    v_lshl_or_b32 v58, v10, 12, v54
    v_lshl_or_b32 v59, v11, 12, v55
K1_JOIN:
    v_lshlrev_b32 v84, 4, v0
    v_lshrrev_b32 v85, 3, v0
    v_lshlrev_b32 v85, 1, v85
    v_and_b32 v86, 0x1ff0, v84
    v_add_u32 v86, 16384, v86
    v_and_b32 v87, 0x7e, v85
    global_load_dwordx4 v[64:67], v84, s[66:67]
    global_load_dwordx4 v[68:71], v84, s[68:69]
    global_load_dwordx4 v[72:75], v86, s[68:69]
    global_load_ushort v76, v85, s[64:65]
    global_load_ushort v77, v85, s[64:65] offset:256
    global_load_ushort v78, v87, s[64:65] offset:512
    v_bfe_u32 v80, v0, 4, 1
    v_lshlrev_b32 v80, 6, v80
    v_xor_b32 v80, v80, v84
    v_add_u32 v80, 102400, v80
    v_lshlrev_b32 v6, 4, v0
    s_mul_i32 s3, s2, 38400
    v_add_u32 v2, s3, v6
    v_add_u32 v3, 16384, v2
    v_add_u32 v4, 32768, v2
    v_cmp_gt_u32 vcc, 352, v0
    s_waitcnt lgkmcnt(0)
    s_barrier
    ds_read_b128 v[8:11], v6 offset:4096
    ds_read_b128 v[12:15], v6 offset:20480
    ds_read_b128 v[16:19], v6 offset:36864
    s_waitcnt lgkmcnt(2)
    global_store_dwordx4 v2, v[8:11], s[26:27] sc1
    s_waitcnt lgkmcnt(1)
    global_store_dwordx4 v3, v[12:15], s[26:27] sc1
    s_and_saveexec_b64 s[28:29], vcc
    s_cbranch_execz K1_FIN
    s_waitcnt lgkmcnt(0)
    global_store_dwordx4 v4, v[16:19], s[26:27] sc1
K1_FIN:
    s_mov_b64 exec, -1
    s_waitcnt vmcnt(2)
    s_mov_b32 s7, 0xffff0000
    v_lshlrev_b32 v76, 16, v76
    v_lshlrev_b32 v82, 16, v64
    v_and_b32 v83, s7, v64
    v_mul_f32 v82, v76, v82
    v_mul_f32 v83, v76, v83
    v_cvt_pk_bf16_f32 v64, v82, v83
    v_lshlrev_b32 v82, 16, v65
    v_and_b32 v83, s7, v65
    v_mul_f32 v82, v76, v82
    v_mul_f32 v83, v76, v83
    v_cvt_pk_bf16_f32 v65, v82, v83
    v_lshlrev_b32 v82, 16, v66
    v_and_b32 v83, s7, v66
    v_mul_f32 v82, v76, v82
    v_mul_f32 v83, v76, v83
    v_cvt_pk_bf16_f32 v66, v82, v83
    v_lshlrev_b32 v82, 16, v67
    v_and_b32 v83, s7, v67
    v_mul_f32 v82, v76, v82
    v_mul_f32 v83, v76, v83
    v_cvt_pk_bf16_f32 v67, v82, v83
    ds_write_b128 v80, v[64:67] offset:0
    v_lshlrev_b32 v77, 16, v77
    v_lshlrev_b32 v82, 16, v68
    v_and_b32 v83, s7, v68
    v_mul_f32 v82, v77, v82
    v_mul_f32 v83, v77, v83
    v_cvt_pk_bf16_f32 v68, v82, v83
    v_lshlrev_b32 v82, 16, v69
    v_and_b32 v83, s7, v69
    v_mul_f32 v82, v77, v82
    v_mul_f32 v83, v77, v83
    v_cvt_pk_bf16_f32 v69, v82, v83
    v_lshlrev_b32 v82, 16, v70
    v_and_b32 v83, s7, v70
    v_mul_f32 v82, v77, v82
    v_mul_f32 v83, v77, v83
    v_cvt_pk_bf16_f32 v70, v82, v83
    v_lshlrev_b32 v82, 16, v71
    v_and_b32 v83, s7, v71
    v_mul_f32 v82, v77, v82
    v_mul_f32 v83, v77, v83
    v_cvt_pk_bf16_f32 v71, v82, v83
    ds_write_b128 v80, v[68:71] offset:16384
    s_cmp_ge_u32 s6, 512
    s_cbranch_scc1 K1_WS1
    v_lshlrev_b32 v78, 16, v78
    v_lshlrev_b32 v82, 16, v72
    v_and_b32 v83, s7, v72
    v_mul_f32 v82, v78, v82
    v_mul_f32 v83, v78, v83
    v_cvt_pk_bf16_f32 v72, v82, v83
    v_lshlrev_b32 v82, 16, v73
    v_and_b32 v83, s7, v73
    v_mul_f32 v82, v78, v82
    v_mul_f32 v83, v78, v83
    v_cvt_pk_bf16_f32 v73, v82, v83
    v_lshlrev_b32 v82, 16, v74
    v_and_b32 v83, s7, v74
    v_mul_f32 v82, v78, v82
    v_mul_f32 v83, v78, v83
    v_cvt_pk_bf16_f32 v74, v82, v83
    v_lshlrev_b32 v82, 16, v75
    v_and_b32 v83, s7, v75
    v_mul_f32 v82, v78, v82
    v_mul_f32 v83, v78, v83
    v_cvt_pk_bf16_f32 v75, v82, v83
    ds_write_b128 v80, v[72:75] offset:32768
K1_WS1:
    s_waitcnt vmcnt(0) lgkmcnt(0)
    s_barrier
    s_cmp_lg_u32 s6, 832
    s_cbranch_scc1 K1_DONE
    v_mov_b32 v62, 143376
    ds_read_b32 v49, v62
    s_lshl_b32 s3, s2, 11
    s_add_u32 s3, s3, 9633792
    v_lshl_add_u32 v2, v1, 1, s3
    s_waitcnt lgkmcnt(0)
    v_lshlrev_b32 v62, 23, v49
    v_and_b32 v62, 0xff000000, v62
    v_or_b32 v48, v62, v56
    v_or_b32 v50, v62, v57
    v_or_b32 v52, v62, v58
    v_or_b32 v54, v62, v59
    v_mov_b32 v51, v49
    v_mov_b32 v53, v49
    v_mov_b32 v55, v49
    global_store_dwordx4 v2, v[48:51], s[26:27] sc1
    global_store_dwordx4 v2, v[52:55], s[26:27] offset:16 sc1
    s_branch K1_DONE
K1_IDLE:
    s_waitcnt lgkmcnt(0)
    v_lshlrev_b32 v84, 4, v0
    v_lshrrev_b32 v85, 3, v0
    v_lshlrev_b32 v85, 1, v85
    v_and_b32 v86, 0x1ff0, v84
    v_add_u32 v86, 16384, v86
    v_and_b32 v87, 0x7e, v85
    global_load_dwordx4 v[64:67], v84, s[66:67]
    global_load_dwordx4 v[68:71], v84, s[68:69]
    global_load_dwordx4 v[72:75], v86, s[68:69]
    global_load_ushort v76, v85, s[64:65]
    global_load_ushort v77, v85, s[64:65] offset:256
    global_load_ushort v78, v87, s[64:65] offset:512
    v_bfe_u32 v80, v0, 4, 1
    v_lshlrev_b32 v80, 6, v80
    v_xor_b32 v80, v80, v84
    v_add_u32 v80, 102400, v80
    s_waitcnt vmcnt(0)
    s_mov_b32 s7, 0xffff0000
    v_lshlrev_b32 v76, 16, v76
    v_lshlrev_b32 v82, 16, v64
    v_and_b32 v83, s7, v64
    v_mul_f32 v82, v76, v82
    v_mul_f32 v83, v76, v83
    v_cvt_pk_bf16_f32 v64, v82, v83
    v_lshlrev_b32 v82, 16, v65
    v_and_b32 v83, s7, v65
    v_mul_f32 v82, v76, v82
    v_mul_f32 v83, v76, v83
    v_cvt_pk_bf16_f32 v65, v82, v83
    v_lshlrev_b32 v82, 16, v66
    v_and_b32 v83, s7, v66
    v_mul_f32 v82, v76, v82
    v_mul_f32 v83, v76, v83
    v_cvt_pk_bf16_f32 v66, v82, v83
    v_lshlrev_b32 v82, 16, v67
    v_and_b32 v83, s7, v67
    v_mul_f32 v82, v76, v82
    v_mul_f32 v83, v76, v83
    v_cvt_pk_bf16_f32 v67, v82, v83
    ds_write_b128 v80, v[64:67] offset:0
    v_lshlrev_b32 v77, 16, v77
    v_lshlrev_b32 v82, 16, v68
    v_and_b32 v83, s7, v68
    v_mul_f32 v82, v77, v82
    v_mul_f32 v83, v77, v83
    v_cvt_pk_bf16_f32 v68, v82, v83
    v_lshlrev_b32 v82, 16, v69
    v_and_b32 v83, s7, v69
    v_mul_f32 v82, v77, v82
    v_mul_f32 v83, v77, v83
    v_cvt_pk_bf16_f32 v69, v82, v83
    v_lshlrev_b32 v82, 16, v70
    v_and_b32 v83, s7, v70
    v_mul_f32 v82, v77, v82
    v_mul_f32 v83, v77, v83
    v_cvt_pk_bf16_f32 v70, v82, v83
    v_lshlrev_b32 v82, 16, v71
    v_and_b32 v83, s7, v71
    v_mul_f32 v82, v77, v82
    v_mul_f32 v83, v77, v83
    v_cvt_pk_bf16_f32 v71, v82, v83
    ds_write_b128 v80, v[68:71] offset:16384
    s_cmp_ge_u32 s6, 512
    s_cbranch_scc1 K1_WS2
    v_lshlrev_b32 v78, 16, v78
    v_lshlrev_b32 v82, 16, v72
    v_and_b32 v83, s7, v72
    v_mul_f32 v82, v78, v82
    v_mul_f32 v83, v78, v83
    v_cvt_pk_bf16_f32 v72, v82, v83
    v_lshlrev_b32 v82, 16, v73
    v_and_b32 v83, s7, v73
    v_mul_f32 v82, v78, v82
    v_mul_f32 v83, v78, v83
    v_cvt_pk_bf16_f32 v73, v82, v83
    v_lshlrev_b32 v82, 16, v74
    v_and_b32 v83, s7, v74
    v_mul_f32 v82, v78, v82
    v_mul_f32 v83, v78, v83
    v_cvt_pk_bf16_f32 v74, v82, v83
    v_lshlrev_b32 v82, 16, v75
    v_and_b32 v83, s7, v75
    v_mul_f32 v82, v78, v82
    v_mul_f32 v83, v78, v83
    v_cvt_pk_bf16_f32 v75, v82, v83
    ds_write_b128 v80, v[72:75] offset:32768
K1_WS2:
    s_cmp_lg_u32 s6, 960
    s_cbranch_scc1 K1_IDLE1
    s_mov_b32 s36, 0
    v_mov_b32 v62, 0
    s_branch K1_TW_L
    s_mov_b32 s36, 0
    v_mov_b32 v62, 0
    global_load_dword v63, v62, s[38:39]
    s_branch K1_TW_W
K1_TW_L:
    global_load_dword v63, v62, s[38:39] sc1
K1_TW_W:
    s_waitcnt vmcnt(0)
    v_readfirstlane_b32 s37, v63
    s_add_u32 s36, s36, 1
    s_cmp_gt_u32 s36, 400000
    s_cbranch_scc1 K2_END
    s_cmp_lg_u32 s37, 0
    s_cbranch_scc1 K1_TW_D
    s_sleep 1
    s_branch K1_TW_L
K1_TW_D:
    v_mov_b32 v62, 143376
    ds_write_b32 v62, v63
K1_IDLE1:
    s_waitcnt lgkmcnt(0)
    s_barrier
K1_DONE:
    v_mov_b32 v97, 143376
    ds_read_b32 v97, v97
    s_lshr_b32 s16, s6, 6
    s_and_b32 s26, s2, 7
    s_lshr_b32 s27, s2, 3
    s_lshl_b32 s22, s26, 5
    s_add_u32 s22, s22, s27
    s_mov_b32 s30, 0
    s_mov_b32 s31, 0
    s_mov_b32 s33, 0
    s_mov_b32 s34, 0
    s_mov_b32 s35, 0
    s_movk_i32 s21, 512
    s_mov_b32 s4, s58
    s_and_b32 s5, s59, 0xffff
    s_mov_b32 s6, 12800000
    s_mov_b32 s7, 0x00020000
    s_mov_b32 s12, s60
    s_and_b32 s13, s61, 0xffff
    s_mov_b32 s14, 12800000
    s_mov_b32 s15, 0x00020000
    s_mov_b32 s8, s56
    s_and_b32 s9, s57, 0xffff
    s_mov_b32 s10, 9600000
    s_mov_b32 s11, 0x00020000
    s_waitcnt lgkmcnt(0)
    v_readfirstlane_b32 s39, v97
    s_nop 3
    s_lshl_b32 s29, s39, 23
    s_and_b32 s29, s29, 0xff000000
K2_ROUND:
    v_lshlrev_b32 v98, 4, v0
    v_and_b32 v112, 63, v0
    s_lshl_b32 s26, s22, 3
    s_add_u32 s26, s26, 9633792
    v_and_b32 v96, 0x3f0, v0
    v_lshl_add_u32 v14, v96, 9, s26
    v_add_u32 v15, 4096, v14
    v_cmp_gt_u32 vcc, 944, v0
    v_mov_b32 v99, 0
    v_mov_b32 v100, 143360
    v_cndmask_b32 v20, 0, -1, vcc
    v_cndmask_b32 v21, 0, -1, vcc
    v_cndmask_b32 v22, 0, -1, vcc
    v_cndmask_b32 v23, 0, -1, vcc
    ds_write_b128 v98, v[20:23] offset:30208
    ds_write_b32 v100, v99
    v_and_b32 v20, 7, v112
    v_bfe_u32 v21, v112, 4, 1
    v_lshlrev_b32 v22, 2, v21
    v_xor_b32 v20, v20, v22
    v_lshlrev_b32 v1, 4, v20
    v_lshrrev_b32 v20, 5, v112
    v_bfe_u32 v22, v112, 2, 2
    v_lshl_add_u32 v23, v20, 2, v22
    v_and_b32 v4, 56, v112
    v_lshlrev_b32 v5, 3, v23
    v_lshlrev_b32 v8, 4, v23
    v_and_b32 v24, 3, v112
    v_lshl_add_u32 v11, v21, 2, v24
    v_lshlrev_b32 v11, 2, v11
    s_lshl_b32 s20, s16, 12
    s_add_u32 s20, s20, 49152
    v_lshlrev_b32 v9, 7, v23
    v_bfe_u32 v25, v112, 3, 1
    v_lshl_add_u32 v9, v25, 6, v9
    v_lshl_add_u32 v9, v21, 5, v9
    v_lshl_add_u32 v9, v24, 3, v9
    v_add_u32 v9, s20, v9
    v_xor_b32 v10, 64, v9
    v_and_b32 v20, 15, v112
    v_lshrrev_b32 v96, 2, v96
    v_mul_u32_u24 v97, 3200, v96
    v_add_u32 v97, v97, v20
    v_add_u32 v97, s33, v97
    v_add_u32 v103, s33, v20
    v_cmp_gt_u32 vcc, 248, v96
    v_lshrrev_b32 v23, 2, v96
    v_cmp_eq_u32 s[62:63], 62, v23
    v_mov_b32 v104, 0
    v_mov_b32 v105, 0
    v_mov_b32 v106, 0
    v_mov_b32 v107, 0
    v_cndmask_b32 v15, v14, v15, vcc
    s_or_b64 s[40:41], vcc, s[62:63]
    s_mov_b64 s[42:43], vcc
    s_mov_b32 s18, 0
    s_and_b32 s26, s16, 7
    s_lshl_b32 s27, s16, 4
    s_add_u32 s26, s26, s27
    s_lshl_b32 s26, s26, 11
    s_lshl_b32 s27, s22, 3
    s_add_u32 s26, s26, s27
    s_add_u32 s26, s26, 9633796
    v_mov_b32 v122, s26
    s_mov_b64 exec, 1
K2_SAMP:
    global_load_dword v114, v122, s[56:57] sc1
    s_add_u32 s18, s18, 1
    s_cmp_gt_u32 s18, 400000
    s_cbranch_scc1 K2_END
    s_waitcnt vmcnt(0)
    v_readfirstlane_b32 s26, v114
    s_nop 3
    s_cmp_eq_u32 s26, s39
    s_cbranch_scc1 K2_SAMPD
    s_sleep 2
    s_branch K2_SAMP
K2_SAMPD:
    s_barrier
    s_mov_b64 exec, s[40:41]
K2_POLL:
    global_load_dwordx2 v[114:115], v14, s[56:57] sc1
    global_load_dwordx2 v[116:117], v14, s[56:57] offset:2048 sc1
    global_load_dwordx2 v[118:119], v15, s[56:57] sc1
    global_load_dwordx2 v[120:121], v15, s[56:57] offset:2048 sc1
K2_POLLW:
    s_add_u32 s18, s18, 1
    s_cmp_gt_u32 s18, 400000
    s_cbranch_scc1 K2_END
    s_waitcnt vmcnt(0)
    v_xor_b32 v115, s39, v115
    v_xor_b32 v114, s29, v114
    v_xor_b32 v117, s39, v117
    v_xor_b32 v116, s29, v116
    v_xor_b32 v119, s39, v119
    v_xor_b32 v118, s29, v118
    v_xor_b32 v121, s39, v121
    v_xor_b32 v120, s29, v120
    v_or3_b32 v115, v115, v117, v119
    v_or3_b32 v117, v114, v116, v118
    v_or_b32 v117, v117, v120
    v_lshrrev_b32 v117, 24, v117
    v_or3_b32 v115, v115, v121, v117
    v_cmp_ne_u32 vcc, 0, v115
    s_and_b64 exec, exec, vcc
    s_cbranch_execz K2_GOT
    s_sleep 2
    s_branch K2_POLL
K2_GOT:
    s_mov_b64 exec, s[40:41]
    v_mov_b32 v104, v114
    v_mov_b32 v105, v116
    s_mov_b64 exec, s[42:43]
    v_mov_b32 v106, v118
    v_mov_b32 v107, v120
    s_mov_b64 exec, -1
    v_lshrrev_b32 v108, 12, v104
    v_and_b32 v104, 0xfff, v104
    v_add_u32 v20, v97, v104
    v_mul_u32_u24 v20, 12, v20
    v_add_u32 v101, 0, v96
    v_and_b32 v101, s35, v101
    v_cmp_eq_u32 vcc, s34, v101
    v_sub_u32 v102, v108, v103
    s_nop 0
    v_cndmask_b32 v102, 0, v102, vcc
    v_cmp_lt_i32 s[40:41], 0, v102
    v_cmp_lt_i32 s[48:49], 16, v102
    v_lshrrev_b32 v109, 12, v105
    v_and_b32 v105, 0xfff, v105
    v_add_u32 v21, v97, v105
    v_mul_u32_u24 v21, 12, v21
    v_add_u32 v101, 1, v96
    v_and_b32 v101, s35, v101
    v_cmp_eq_u32 vcc, s34, v101
    v_sub_u32 v102, v109, v103
    s_nop 0
    v_cndmask_b32 v102, 0, v102, vcc
    v_cmp_lt_i32 s[42:43], 0, v102
    v_cmp_lt_i32 s[50:51], 16, v102
    v_lshrrev_b32 v110, 12, v106
    v_and_b32 v106, 0xfff, v106
    v_add_u32 v22, v97, v106
    v_mul_u32_u24 v22, 12, v22
    v_add_u32 v101, 2, v96
    v_and_b32 v101, s35, v101
    v_cmp_eq_u32 vcc, s34, v101
    v_sub_u32 v102, v110, v103
    s_nop 0
    v_cndmask_b32 v102, 0, v102, vcc
    v_cmp_lt_i32 s[44:45], 0, v102
    v_cmp_lt_i32 s[52:53], 16, v102
    v_lshrrev_b32 v111, 12, v107
    v_and_b32 v107, 0xfff, v107
    v_add_u32 v23, v97, v107
    v_mul_u32_u24 v23, 12, v23
    v_add_u32 v101, 3, v96
    v_and_b32 v101, s35, v101
    v_cmp_eq_u32 vcc, s34, v101
    v_sub_u32 v102, v111, v103
    s_nop 0
    v_cndmask_b32 v102, 0, v102, vcc
    v_cmp_lt_i32 s[46:47], 0, v102
    v_cmp_lt_i32 s[54:55], 16, v102
    s_mov_b32 s26, 38400
    s_mov_b32 s27, 76800
    s_mov_b32 s28, 115200
    s_mov_b64 exec, s[40:41]
    s_cbranch_execz K2_LD0
    buffer_load_dwordx3 v[32:34], v20, s[8:11], 0 offen offset:0 sc1
K2_LD0:
    s_mov_b64 exec, s[42:43]
    s_cbranch_execz K2_LD1
    buffer_load_dwordx3 v[36:38], v21, s[8:11], s26 offen offset:0 sc1
K2_LD1:
    s_mov_b64 exec, s[44:45]
    s_cbranch_execz K2_LD2
    buffer_load_dwordx3 v[40:42], v22, s[8:11], s27 offen offset:0 sc1
K2_LD2:
    s_mov_b64 exec, s[46:47]
    s_cbranch_execz K2_LD3
    buffer_load_dwordx3 v[44:46], v23, s[8:11], s28 offen offset:0 sc1
K2_LD3:
    s_mov_b64 exec, s[48:49]
    s_cbranch_execz K2_LD4
    buffer_load_dwordx3 v[48:50], v20, s[8:11], 0 offen offset:192 sc1
K2_LD4:
    s_mov_b64 exec, s[50:51]
    s_cbranch_execz K2_LD5
    buffer_load_dwordx3 v[52:54], v21, s[8:11], s26 offen offset:192 sc1
K2_LD5:
    s_mov_b64 exec, s[52:53]
    s_cbranch_execz K2_LD6
    buffer_load_dwordx3 v[56:58], v22, s[8:11], s27 offen offset:192 sc1
K2_LD6:
    s_mov_b64 exec, s[54:55]
    s_cbranch_execz K2_LD7
    buffer_load_dwordx3 v[60:62], v23, s[8:11], s28 offen offset:192 sc1
K2_LD7:
    s_mov_b64 exec, -1
    s_waitcnt lgkmcnt(0)
    s_barrier
    s_mul_i32 s26, s2, 50176
    v_cmp_gt_u32 vcc, 392, v0
    v_lshlrev_b32 v101, 7, v0
    v_mov_b32 v102, 0x40000000
    v_cndmask_b32 v101, v102, v101, vcc
    buffer_load_dword v13, v101, s[4:7], s26 offen
    v_max_u32 v101, v108, v109
    v_max3_u32 v101, v101, v110, v111
    v_cmp_lt_u32 vcc, 32, v101
    s_and_saveexec_b64 s[62:63], vcc
    s_cbranch_execz K2_NOOVF
    ds_max_u32 v100, v101
K2_NOOVF:
    s_mov_b64 exec, -1
    v_mov_b32 v96, 1
    s_waitcnt vmcnt(1)
    s_mov_b64 exec, s[40:41]
    s_cbranch_execz K2_AT0
    v_lshrrev_b32 v20, 24, v34
    v_lshlrev_b32 v20, 2, v20
    ds_add_rtn_u32 v35, v20, v96 offset:45312
K2_AT0:
    s_mov_b64 exec, s[42:43]
    s_cbranch_execz K2_AT1
    v_lshrrev_b32 v21, 24, v38
    v_lshlrev_b32 v21, 2, v21
    ds_add_rtn_u32 v39, v21, v96 offset:45312
K2_AT1:
    s_mov_b64 exec, s[44:45]
    s_cbranch_execz K2_AT2
    v_lshrrev_b32 v22, 24, v42
    v_lshlrev_b32 v22, 2, v22
    ds_add_rtn_u32 v43, v22, v96 offset:45312
K2_AT2:
    s_mov_b64 exec, s[46:47]
    s_cbranch_execz K2_AT3
    v_lshrrev_b32 v23, 24, v46
    v_lshlrev_b32 v23, 2, v23
    ds_add_rtn_u32 v47, v23, v96 offset:45312
K2_AT3:
    s_mov_b64 exec, s[48:49]
    s_cbranch_execz K2_AT4
    v_lshrrev_b32 v24, 24, v50
    v_lshlrev_b32 v24, 2, v24
    ds_add_rtn_u32 v51, v24, v96 offset:45312
K2_AT4:
    s_mov_b64 exec, s[50:51]
    s_cbranch_execz K2_AT5
    v_lshrrev_b32 v25, 24, v54
    v_lshlrev_b32 v25, 2, v25
    ds_add_rtn_u32 v55, v25, v96 offset:45312
K2_AT5:
    s_mov_b64 exec, s[52:53]
    s_cbranch_execz K2_AT6
    v_lshrrev_b32 v26, 24, v58
    v_lshlrev_b32 v26, 2, v26
    ds_add_rtn_u32 v59, v26, v96 offset:45312
K2_AT6:
    s_mov_b64 exec, s[54:55]
    s_cbranch_execz K2_AT7
    v_lshrrev_b32 v27, 24, v62
    v_lshlrev_b32 v27, 2, v27
    ds_add_rtn_u32 v63, v27, v96 offset:45312
K2_AT7:
    s_mov_b64 exec, -1
    s_waitcnt lgkmcnt(0)
    s_barrier
    v_lshlrev_b32 v96, 4, v112
    ds_read_b128 v[28:31], v96 offset:45312
    ds_read_b32 v100, v100
    s_waitcnt lgkmcnt(0)
    v_add_u32 v97, v28, v29
    v_add_u32 v98, v97, v30
    v_add_u32 v99, v98, v31
    s_nop 1
    v_add_u32_dpp v104, v99, v99 quad_perm:[1,0,3,2] row_mask:0xf bank_mask:0xf
    s_nop 1
    v_add_u32_dpp v104, v104, v104 quad_perm:[2,3,0,1] row_mask:0xf bank_mask:0xf
    v_and_b32 v107, 3, v112
    v_cmp_eq_u32 vcc, 3, v107
    v_add_u32 v105, 15, v104
    v_and_b32 v105, -16, v105
    v_max_u32 v105, 48, v105
    v_sub_u32 v106, v105, v104
    v_cndmask_b32 v106, 0, v106, vcc
    v_add_u32 v99, v99, v106
    v_mov_b32 v104, v99
    s_nop 1
    v_add_u32_dpp v104, v104, v104 row_shr:1 row_mask:0xf bank_mask:0xf bound_ctrl:0
    s_nop 1
    v_add_u32_dpp v104, v104, v104 row_shr:2 row_mask:0xf bank_mask:0xf bound_ctrl:0
    s_nop 1
    v_add_u32_dpp v104, v104, v104 row_shr:4 row_mask:0xf bank_mask:0xf bound_ctrl:0
    s_nop 1
    v_add_u32_dpp v104, v104, v104 row_shr:8 row_mask:0xf bank_mask:0xf bound_ctrl:0
    s_nop 1
    v_add_u32_dpp v104, v104, v104 row_bcast:15 row_mask:0xa bank_mask:0xf
    s_nop 1
    v_add_u32_dpp v104, v104, v104 row_bcast:31 row_mask:0xc bank_mask:0xf
    v_sub_u32 v104, v104, v99
    v_add_u32 v29, v104, v28
    v_add_u32 v30, v104, v97
    v_add_u32 v31, v104, v98
    v_mov_b32 v28, v104
    ds_write_b128 v96, v[28:31] offset:46336
    s_lshl_b32 s26, s16, 2
    v_readlane_b32 s27, v104, 52
    v_readfirstlane_b32 s62, v100
    v_readlane_b32 s28, v104, s26
    v_readlane_b32 s17, v105, s26
    s_mov_b64 exec, s[40:41]
    s_cbranch_execz K2_RB0
    ds_read_b32 v20, v20 offset:46336
K2_RB0:
    s_mov_b64 exec, s[42:43]
    s_cbranch_execz K2_RB1
    ds_read_b32 v21, v21 offset:46336
K2_RB1:
    s_mov_b64 exec, s[44:45]
    s_cbranch_execz K2_RB2
    ds_read_b32 v22, v22 offset:46336
K2_RB2:
    s_mov_b64 exec, s[46:47]
    s_cbranch_execz K2_RB3
    ds_read_b32 v23, v23 offset:46336
K2_RB3:
    s_mov_b64 exec, s[48:49]
    s_cbranch_execz K2_RB4
    ds_read_b32 v24, v24 offset:46336
K2_RB4:
    s_mov_b64 exec, s[50:51]
    s_cbranch_execz K2_RB5
    ds_read_b32 v25, v25 offset:46336
K2_RB5:
    s_mov_b64 exec, s[52:53]
    s_cbranch_execz K2_RB6
    ds_read_b32 v26, v26 offset:46336
K2_RB6:
    s_mov_b64 exec, s[54:55]
    s_cbranch_execz K2_RB7
    ds_read_b32 v27, v27 offset:46336
K2_RB7:
    s_mov_b64 exec, -1
    s_cmp_lg_u32 s30, 0
    s_cbranch_scc1 K2_OK
    s_cmp_gt_u32 s27, 3776
    s_cbranch_scc1 K2_GOSLOW
    s_cmp_eq_u32 s62, 0
    s_cbranch_scc1 K2_OK
K2_GOSLOW:
    s_mov_b32 s30, 1
    s_mov_b32 s35, 3
    s_max_u32 s62, s62, 1
    s_add_u32 s62, s62, 31
    s_lshr_b32 s62, s62, 5
    s_lshl_b32 s32, s62, 2
    s_waitcnt vmcnt(0) lgkmcnt(0)
    s_barrier
    s_branch K2_ROUND
K2_OK:
    s_lshl_b32 s26, s28, 2
    s_add_u32 s26, s26, 30208
    v_add_u32 v4, s26, v4
    v_add_u32 v5, s26, v5
    s_lshl_b32 s26, s28, 3
    v_add_u32 v8, s26, v8
    s_lshr_b32 s17, s17, 4
    s_sub_u32 s17, s17, 2
    s_waitcnt lgkmcnt(0)
    s_mov_b64 exec, s[40:41]
    s_cbranch_execz K2_SC0
    v_add_lshl_u32 v20, v20, v35, 2
    v_lshlrev_b32 v96, 1, v20
    ds_write_b32 v20, v34 offset:30208
    ds_write_b64 v96, v[32:33] offset:0
K2_SC0:
    s_mov_b64 exec, s[42:43]
    s_cbranch_execz K2_SC1
    v_add_lshl_u32 v21, v21, v39, 2
    v_lshlrev_b32 v96, 1, v21
    ds_write_b32 v21, v38 offset:30208
    ds_write_b64 v96, v[36:37] offset:0
K2_SC1:
    s_mov_b64 exec, s[44:45]
    s_cbranch_execz K2_SC2
    v_add_lshl_u32 v22, v22, v43, 2
    v_lshlrev_b32 v96, 1, v22
    ds_write_b32 v22, v42 offset:30208
    ds_write_b64 v96, v[40:41] offset:0
K2_SC2:
    s_mov_b64 exec, s[46:47]
    s_cbranch_execz K2_SC3
    v_add_lshl_u32 v23, v23, v47, 2
    v_lshlrev_b32 v96, 1, v23
    ds_write_b32 v23, v46 offset:30208
    ds_write_b64 v96, v[44:45] offset:0
K2_SC3:
    s_mov_b64 exec, s[48:49]
    s_cbranch_execz K2_SC4
    v_add_lshl_u32 v24, v24, v51, 2
    v_lshlrev_b32 v96, 1, v24
    ds_write_b32 v24, v50 offset:30208
    ds_write_b64 v96, v[48:49] offset:0
K2_SC4:
    s_mov_b64 exec, s[50:51]
    s_cbranch_execz K2_SC5
    v_add_lshl_u32 v25, v25, v55, 2
    v_lshlrev_b32 v96, 1, v25
    ds_write_b32 v25, v54 offset:30208
    ds_write_b64 v96, v[52:53] offset:0
K2_SC5:
    s_mov_b64 exec, s[52:53]
    s_cbranch_execz K2_SC6
    v_add_lshl_u32 v26, v26, v59, 2
    v_lshlrev_b32 v96, 1, v26
    ds_write_b32 v26, v58 offset:30208
    ds_write_b64 v96, v[56:57] offset:0
K2_SC6:
    s_mov_b64 exec, s[54:55]
    s_cbranch_execz K2_SC7
    v_add_lshl_u32 v27, v27, v63, 2
    v_lshlrev_b32 v96, 1, v27
    ds_write_b32 v27, v62 offset:30208
    ds_write_b64 v96, v[60:61] offset:0
K2_SC7:
    s_mov_b64 exec, -1
    s_mov_b32 s23, 0
    s_mov_b32 s19, 0
    s_waitcnt lgkmcnt(0)
    s_barrier
    s_cmp_ge_u32 s16, 13
    s_cbranch_scc1 K2_RIDLE
    s_mov_b32 s24, s20
    ds_read_b64 v[14:15], v4
    ds_read_b64 v[20:21], v4 offset:64
    ds_read_b64 v[16:17], v5
    s_waitcnt lgkmcnt(2)
    v_mad_u32_u16 v14, v14, s21, v1
    v_mad_u32_u16 v15, v15, s21, v1
    s_mov_b32 m0, s24
    s_nop 0
    buffer_load_dwordx4 v14, s[4:7], s19 offen lds
    s_add_u32 m0, s24, 1024
    s_xor_b32 s24, s24, 0x800
    buffer_load_dwordx4 v15, s[4:7], s19 offen lds
    s_waitcnt lgkmcnt(1)
    v_mad_u32_u16 v14, v20, s21, v1
    v_mad_u32_u16 v15, v21, s21, v1
    s_mov_b32 m0, s24
    s_nop 0
    buffer_load_dwordx4 v14, s[4:7], s19 offen lds
    s_add_u32 m0, s24, 1024
    s_xor_b32 s24, s24, 0x800
    buffer_load_dwordx4 v15, s[4:7], s19 offen lds
    v_mov_b32 v96, 0
    v_mov_b32 v97, 0
    v_mov_b32 v98, 0
    v_mov_b32 v99, 0
    v_mov_b32 v100, 0
    v_mov_b32 v101, 0
    v_mov_b32 v102, 0
    v_mov_b32 v103, 0
    v_mov_b32 v104, 0
    v_mov_b32 v105, 0
    v_mov_b32 v106, 0
    v_mov_b32 v107, 0
    v_mov_b32 v108, 0
    v_mov_b32 v109, 0
    v_mov_b32 v110, 0
    v_mov_b32 v111, 0
    s_setprio 3
K2_PHASE:
    v_mov_b32 v32, 0
    v_mov_b32 v33, 0
    v_mov_b32 v34, 0
    v_mov_b32 v35, 0
    v_mov_b32 v36, 0
    v_mov_b32 v37, 0
    v_mov_b32 v38, 0
    v_mov_b32 v39, 0
    v_mov_b32 v40, 0
    v_mov_b32 v41, 0
    v_mov_b32 v42, 0
    v_mov_b32 v43, 0
    v_mov_b32 v44, 0
    v_mov_b32 v45, 0
    v_mov_b32 v46, 0
    v_mov_b32 v47, 0
    v_mov_b32 v48, 0
    v_mov_b32 v49, 0
    v_mov_b32 v50, 0
    v_mov_b32 v51, 0
    v_mov_b32 v52, 0
    v_mov_b32 v53, 0
    v_mov_b32 v54, 0
    v_mov_b32 v55, 0
    v_mov_b32 v56, 0
    v_mov_b32 v57, 0
    v_mov_b32 v58, 0
    v_mov_b32 v59, 0
    v_mov_b32 v60, 0
    v_mov_b32 v61, 0
    v_mov_b32 v62, 0
    v_mov_b32 v63, 0
    v_mov_b32 v2, v4
    v_mov_b32 v3, v5
    v_mov_b32 v6, v8
    v_mov_b32 v7, v8
    s_mov_b32 s18, 0
K2_LOOP:
    s_waitcnt lgkmcnt(0)
    v_xor_b32_sdwa v6, v16, v11 dst_sel:WORD_1 dst_unused:UNUSED_PRESERVE src0_sel:BYTE_2 src1_sel:WORD_0
    v_xor_b32_sdwa v7, v17, v11 dst_sel:WORD_1 dst_unused:UNUSED_PRESERVE src0_sel:BYTE_2 src1_sel:WORD_0
    ds_read_b64 v[14:15], v2 offset:128
    ds_read_b64_tr_b16 v[28:29], v6 offset:0
    ds_read_b64_tr_b16 v[30:31], v7 offset:8
    v_add_u32 v2, 64, v2
    v_add_u32 v6, 128, v6
    v_add_u32 v7, 128, v7
    s_add_u32 s18, s18, 1
    s_waitcnt vmcnt(2)
    ds_read_b64_tr_b16 v[20:21], v9
    ds_read_b64_tr_b16 v[22:23], v9 offset:1024
    ds_read_b64_tr_b16 v[24:25], v10
    ds_read_b64_tr_b16 v[26:27], v10 offset:1024
    v_xor_b32 v9, 0x800, v9
    v_xor_b32 v10, 0x800, v10
    s_waitcnt lgkmcnt(6)
    v_mad_u32_u16 v14, v14, s21, v1
    v_mad_u32_u16 v15, v15, s21, v1
    s_mov_b32 m0, s24
    s_waitcnt lgkmcnt(0)
    buffer_load_dwordx4 v14, s[4:7], s19 offen lds
    s_add_u32 m0, s24, 1024
    s_xor_b32 s24, s24, 0x800
    buffer_load_dwordx4 v15, s[4:7], s19 offen lds
    ds_read_b64 v[16:17], v3 offset:64
    v_add_u32 v3, 64, v3
    v_mfma_f32_32x32x16_bf16 v[32:47], v[20:23], v[28:31], v[32:47]
    v_mfma_f32_32x32x16_bf16 v[48:63], v[24:27], v[28:31], v[48:63]
    s_cmp_lt_u32 s18, s17
    s_cbranch_scc1 K2_LOOP
    s_add_u32 s19, s19, 128
    s_cmp_eq_u32 s23, 3
    s_cbranch_scc1 K2_TAIL3
    s_waitcnt lgkmcnt(0)
    v_xor_b32_sdwa v6, v16, v11 dst_sel:WORD_1 dst_unused:UNUSED_PRESERVE src0_sel:BYTE_2 src1_sel:WORD_0
    v_xor_b32_sdwa v7, v17, v11 dst_sel:WORD_1 dst_unused:UNUSED_PRESERVE src0_sel:BYTE_2 src1_sel:WORD_0
    ds_read_b64 v[14:15], v4 offset:0
    ds_read_b64_tr_b16 v[28:29], v6 offset:0
    ds_read_b64_tr_b16 v[30:31], v7 offset:8
    s_waitcnt vmcnt(2)
    ds_read_b64_tr_b16 v[20:21], v9
    ds_read_b64_tr_b16 v[22:23], v9 offset:1024
    ds_read_b64_tr_b16 v[24:25], v10
    ds_read_b64_tr_b16 v[26:27], v10 offset:1024
    v_xor_b32 v9, 0x800, v9
    v_xor_b32 v10, 0x800, v10
    s_waitcnt lgkmcnt(6)
    v_mad_u32_u16 v14, v14, s21, v1
    v_mad_u32_u16 v15, v15, s21, v1
    s_mov_b32 m0, s24
    s_waitcnt lgkmcnt(0)
    buffer_load_dwordx4 v14, s[4:7], s19 offen lds
    s_add_u32 m0, s24, 1024
    s_xor_b32 s24, s24, 0x800
    buffer_load_dwordx4 v15, s[4:7], s19 offen lds
    ds_read_b64 v[16:17], v3 offset:64
    v_mfma_f32_32x32x16_bf16 v[32:47], v[20:23], v[28:31], v[32:47]
    v_mfma_f32_32x32x16_bf16 v[48:63], v[24:27], v[28:31], v[48:63]
    s_waitcnt lgkmcnt(0)
    v_xor_b32_sdwa v6, v16, v11 dst_sel:WORD_1 dst_unused:UNUSED_PRESERVE src0_sel:BYTE_2 src1_sel:WORD_0
    v_xor_b32_sdwa v7, v17, v11 dst_sel:WORD_1 dst_unused:UNUSED_PRESERVE src0_sel:BYTE_2 src1_sel:WORD_0
    ds_read_b64 v[14:15], v4 offset:64
    ds_read_b64_tr_b16 v[28:29], v6 offset:128
    ds_read_b64_tr_b16 v[30:31], v7 offset:136
    s_waitcnt vmcnt(2)
    ds_read_b64_tr_b16 v[20:21], v9
    ds_read_b64_tr_b16 v[22:23], v9 offset:1024
    ds_read_b64_tr_b16 v[24:25], v10
    ds_read_b64_tr_b16 v[26:27], v10 offset:1024
    v_xor_b32 v9, 0x800, v9
    v_xor_b32 v10, 0x800, v10
    s_waitcnt lgkmcnt(6)
    v_mad_u32_u16 v14, v14, s21, v1
    v_mad_u32_u16 v15, v15, s21, v1
    s_mov_b32 m0, s24
    s_waitcnt lgkmcnt(0)
    buffer_load_dwordx4 v14, s[4:7], s19 offen lds
    s_add_u32 m0, s24, 1024
    s_xor_b32 s24, s24, 0x800
    buffer_load_dwordx4 v15, s[4:7], s19 offen lds
    ds_read_b64 v[16:17], v5 offset:0
    v_mfma_f32_32x32x16_bf16 v[32:47], v[20:23], v[28:31], v[32:47]
    v_mfma_f32_32x32x16_bf16 v[48:63], v[24:27], v[28:31], v[48:63]
    s_branch K2_COMB
K2_TAIL3:
    s_waitcnt lgkmcnt(0)
    v_xor_b32_sdwa v6, v16, v11 dst_sel:WORD_1 dst_unused:UNUSED_PRESERVE src0_sel:BYTE_2 src1_sel:WORD_0
    v_xor_b32_sdwa v7, v17, v11 dst_sel:WORD_1 dst_unused:UNUSED_PRESERVE src0_sel:BYTE_2 src1_sel:WORD_0
    s_nop 0
    ds_read_b64_tr_b16 v[28:29], v6 offset:0
    ds_read_b64_tr_b16 v[30:31], v7 offset:8
    s_waitcnt vmcnt(2)
    ds_read_b64_tr_b16 v[20:21], v9
    ds_read_b64_tr_b16 v[22:23], v9 offset:1024
    ds_read_b64_tr_b16 v[24:25], v10
    ds_read_b64_tr_b16 v[26:27], v10 offset:1024
    v_xor_b32 v9, 0x800, v9
    v_xor_b32 v10, 0x800, v10
    s_waitcnt lgkmcnt(0)
    ds_read_b64 v[16:17], v3 offset:64
    v_mfma_f32_32x32x16_bf16 v[32:47], v[20:23], v[28:31], v[32:47]
    v_mfma_f32_32x32x16_bf16 v[48:63], v[24:27], v[28:31], v[48:63]
    s_waitcnt lgkmcnt(0)
    v_xor_b32_sdwa v6, v16, v11 dst_sel:WORD_1 dst_unused:UNUSED_PRESERVE src0_sel:BYTE_2 src1_sel:WORD_0
    v_xor_b32_sdwa v7, v17, v11 dst_sel:WORD_1 dst_unused:UNUSED_PRESERVE src0_sel:BYTE_2 src1_sel:WORD_0
    s_nop 0
    ds_read_b64_tr_b16 v[28:29], v6 offset:128
    ds_read_b64_tr_b16 v[30:31], v7 offset:136
    s_waitcnt vmcnt(0)
    ds_read_b64_tr_b16 v[20:21], v9
    ds_read_b64_tr_b16 v[22:23], v9 offset:1024
    ds_read_b64_tr_b16 v[24:25], v10
    ds_read_b64_tr_b16 v[26:27], v10 offset:1024
    v_xor_b32 v9, 0x800, v9
    v_xor_b32 v10, 0x800, v10
    s_waitcnt lgkmcnt(0)
    ds_read_b64 v[16:17], v5 offset:0
    v_mfma_f32_32x32x16_bf16 v[32:47], v[20:23], v[28:31], v[32:47]
    v_mfma_f32_32x32x16_bf16 v[48:63], v[24:27], v[28:31], v[48:63]
K2_COMB:
    v_and_b32 v20, 3, v0
    s_add_u32 s26, s23, 2
    s_cmp_gt_u32 s26, 3
    s_cselect_b32 s27, 3, 0
    s_sub_u32 s26, s26, s27
    v_cmp_eq_u32 vcc, s26, v20
    v_mov_b32 v12, 1.0
    s_nop 0
    v_cndmask_b32 v12, v12, -1.0, vcc
    v_cmp_ne_u32 vcc, s23, v20
    s_cmp_eq_u32 s23, 2
    s_nop 0
    v_cndmask_b32 v12, 0, v12, vcc
    s_cbranch_scc1 K2_C2
    s_cmp_eq_u32 s23, 1
    s_cbranch_scc1 K2_C1
    s_cmp_eq_u32 s23, 3
    s_cbranch_scc1 K2_C3
    s_setprio 2
    v_cvt_pk_bf16_f32 v112, v32, v33
    v_cvt_pk_bf16_f32 v113, v34, v35
    v_cvt_pk_bf16_f32 v114, v36, v37
    v_cvt_pk_bf16_f32 v115, v38, v39
    v_cvt_pk_bf16_f32 v116, v40, v41
    v_cvt_pk_bf16_f32 v117, v42, v43
    v_cvt_pk_bf16_f32 v118, v44, v45
    v_cvt_pk_bf16_f32 v119, v46, v47
    v_cvt_pk_bf16_f32 v120, v48, v49
    v_cvt_pk_bf16_f32 v121, v50, v51
    v_cvt_pk_bf16_f32 v122, v52, v53
    v_cvt_pk_bf16_f32 v123, v54, v55
    v_cvt_pk_bf16_f32 v124, v56, v57
    v_cvt_pk_bf16_f32 v125, v58, v59
    v_cvt_pk_bf16_f32 v126, v60, v61
    v_cvt_pk_bf16_f32 v127, v62, v63
    s_branch K2_CEND
K2_C1:
    s_setprio 2
    v_mul_f32_dpp v64, v32, v12 quad_perm:[1,0,3,2] row_mask:0xf bank_mask:0xf
    v_mul_f32_dpp v65, v33, v12 quad_perm:[1,0,3,2] row_mask:0xf bank_mask:0xf
    v_mul_f32_dpp v66, v34, v12 quad_perm:[1,0,3,2] row_mask:0xf bank_mask:0xf
    v_mul_f32_dpp v67, v35, v12 quad_perm:[1,0,3,2] row_mask:0xf bank_mask:0xf
    v_mul_f32_dpp v68, v36, v12 quad_perm:[1,0,3,2] row_mask:0xf bank_mask:0xf
    v_mul_f32_dpp v69, v37, v12 quad_perm:[1,0,3,2] row_mask:0xf bank_mask:0xf
    v_mul_f32_dpp v70, v38, v12 quad_perm:[1,0,3,2] row_mask:0xf bank_mask:0xf
    v_mul_f32_dpp v71, v39, v12 quad_perm:[1,0,3,2] row_mask:0xf bank_mask:0xf
    v_mul_f32_dpp v72, v40, v12 quad_perm:[1,0,3,2] row_mask:0xf bank_mask:0xf
    v_mul_f32_dpp v73, v41, v12 quad_perm:[1,0,3,2] row_mask:0xf bank_mask:0xf
    v_mul_f32_dpp v74, v42, v12 quad_perm:[1,0,3,2] row_mask:0xf bank_mask:0xf
    v_mul_f32_dpp v75, v43, v12 quad_perm:[1,0,3,2] row_mask:0xf bank_mask:0xf
    v_mul_f32_dpp v76, v44, v12 quad_perm:[1,0,3,2] row_mask:0xf bank_mask:0xf
    v_mul_f32_dpp v77, v45, v12 quad_perm:[1,0,3,2] row_mask:0xf bank_mask:0xf
    v_mul_f32_dpp v78, v46, v12 quad_perm:[1,0,3,2] row_mask:0xf bank_mask:0xf
    v_mul_f32_dpp v79, v47, v12 quad_perm:[1,0,3,2] row_mask:0xf bank_mask:0xf
    v_mul_f32_dpp v80, v48, v12 quad_perm:[1,0,3,2] row_mask:0xf bank_mask:0xf
    v_mul_f32_dpp v81, v49, v12 quad_perm:[1,0,3,2] row_mask:0xf bank_mask:0xf
    v_mul_f32_dpp v82, v50, v12 quad_perm:[1,0,3,2] row_mask:0xf bank_mask:0xf
    v_mul_f32_dpp v83, v51, v12 quad_perm:[1,0,3,2] row_mask:0xf bank_mask:0xf
    v_mul_f32_dpp v84, v52, v12 quad_perm:[1,0,3,2] row_mask:0xf bank_mask:0xf
    v_mul_f32_dpp v85, v53, v12 quad_perm:[1,0,3,2] row_mask:0xf bank_mask:0xf
    v_mul_f32_dpp v86, v54, v12 quad_perm:[1,0,3,2] row_mask:0xf bank_mask:0xf
    v_mul_f32_dpp v87, v55, v12 quad_perm:[1,0,3,2] row_mask:0xf bank_mask:0xf
    v_mul_f32_dpp v88, v56, v12 quad_perm:[1,0,3,2] row_mask:0xf bank_mask:0xf
    v_mul_f32_dpp v89, v57, v12 quad_perm:[1,0,3,2] row_mask:0xf bank_mask:0xf
    v_mul_f32_dpp v90, v58, v12 quad_perm:[1,0,3,2] row_mask:0xf bank_mask:0xf
    v_mul_f32_dpp v91, v59, v12 quad_perm:[1,0,3,2] row_mask:0xf bank_mask:0xf
    v_mul_f32_dpp v92, v60, v12 quad_perm:[1,0,3,2] row_mask:0xf bank_mask:0xf
    v_mul_f32_dpp v93, v61, v12 quad_perm:[1,0,3,2] row_mask:0xf bank_mask:0xf
    v_mul_f32_dpp v94, v62, v12 quad_perm:[1,0,3,2] row_mask:0xf bank_mask:0xf
    v_mul_f32_dpp v95, v63, v12 quad_perm:[1,0,3,2] row_mask:0xf bank_mask:0xf
    s_branch K2_CK
K2_C2:
    s_setprio 1
    v_fmac_f32_dpp v64, v32, v12 quad_perm:[2,3,0,1] row_mask:0xf bank_mask:0xf
    v_fmac_f32_dpp v65, v33, v12 quad_perm:[2,3,0,1] row_mask:0xf bank_mask:0xf
    v_fmac_f32_dpp v66, v34, v12 quad_perm:[2,3,0,1] row_mask:0xf bank_mask:0xf
    v_fmac_f32_dpp v67, v35, v12 quad_perm:[2,3,0,1] row_mask:0xf bank_mask:0xf
    v_fmac_f32_dpp v68, v36, v12 quad_perm:[2,3,0,1] row_mask:0xf bank_mask:0xf
    v_fmac_f32_dpp v69, v37, v12 quad_perm:[2,3,0,1] row_mask:0xf bank_mask:0xf
    v_fmac_f32_dpp v70, v38, v12 quad_perm:[2,3,0,1] row_mask:0xf bank_mask:0xf
    v_fmac_f32_dpp v71, v39, v12 quad_perm:[2,3,0,1] row_mask:0xf bank_mask:0xf
    v_fmac_f32_dpp v72, v40, v12 quad_perm:[2,3,0,1] row_mask:0xf bank_mask:0xf
    v_fmac_f32_dpp v73, v41, v12 quad_perm:[2,3,0,1] row_mask:0xf bank_mask:0xf
    v_fmac_f32_dpp v74, v42, v12 quad_perm:[2,3,0,1] row_mask:0xf bank_mask:0xf
    v_fmac_f32_dpp v75, v43, v12 quad_perm:[2,3,0,1] row_mask:0xf bank_mask:0xf
    v_fmac_f32_dpp v76, v44, v12 quad_perm:[2,3,0,1] row_mask:0xf bank_mask:0xf
    v_fmac_f32_dpp v77, v45, v12 quad_perm:[2,3,0,1] row_mask:0xf bank_mask:0xf
    v_fmac_f32_dpp v78, v46, v12 quad_perm:[2,3,0,1] row_mask:0xf bank_mask:0xf
    v_fmac_f32_dpp v79, v47, v12 quad_perm:[2,3,0,1] row_mask:0xf bank_mask:0xf
    v_fmac_f32_dpp v80, v48, v12 quad_perm:[2,3,0,1] row_mask:0xf bank_mask:0xf
    v_fmac_f32_dpp v81, v49, v12 quad_perm:[2,3,0,1] row_mask:0xf bank_mask:0xf
    v_fmac_f32_dpp v82, v50, v12 quad_perm:[2,3,0,1] row_mask:0xf bank_mask:0xf
    v_fmac_f32_dpp v83, v51, v12 quad_perm:[2,3,0,1] row_mask:0xf bank_mask:0xf
    v_fmac_f32_dpp v84, v52, v12 quad_perm:[2,3,0,1] row_mask:0xf bank_mask:0xf
    v_fmac_f32_dpp v85, v53, v12 quad_perm:[2,3,0,1] row_mask:0xf bank_mask:0xf
    v_fmac_f32_dpp v86, v54, v12 quad_perm:[2,3,0,1] row_mask:0xf bank_mask:0xf
    v_fmac_f32_dpp v87, v55, v12 quad_perm:[2,3,0,1] row_mask:0xf bank_mask:0xf
    v_fmac_f32_dpp v88, v56, v12 quad_perm:[2,3,0,1] row_mask:0xf bank_mask:0xf
    v_fmac_f32_dpp v89, v57, v12 quad_perm:[2,3,0,1] row_mask:0xf bank_mask:0xf
    v_fmac_f32_dpp v90, v58, v12 quad_perm:[2,3,0,1] row_mask:0xf bank_mask:0xf
    v_fmac_f32_dpp v91, v59, v12 quad_perm:[2,3,0,1] row_mask:0xf bank_mask:0xf
    v_fmac_f32_dpp v92, v60, v12 quad_perm:[2,3,0,1] row_mask:0xf bank_mask:0xf
    v_fmac_f32_dpp v93, v61, v12 quad_perm:[2,3,0,1] row_mask:0xf bank_mask:0xf
    v_fmac_f32_dpp v94, v62, v12 quad_perm:[2,3,0,1] row_mask:0xf bank_mask:0xf
    v_fmac_f32_dpp v95, v63, v12 quad_perm:[2,3,0,1] row_mask:0xf bank_mask:0xf
    s_branch K2_CK
K2_C3:
    s_setprio 0
    v_fmac_f32_dpp v64, v32, v12 quad_perm:[3,2,1,0] row_mask:0xf bank_mask:0xf
    v_fmac_f32_dpp v65, v33, v12 quad_perm:[3,2,1,0] row_mask:0xf bank_mask:0xf
    v_fmac_f32_dpp v66, v34, v12 quad_perm:[3,2,1,0] row_mask:0xf bank_mask:0xf
    v_fmac_f32_dpp v67, v35, v12 quad_perm:[3,2,1,0] row_mask:0xf bank_mask:0xf
    v_fmac_f32_dpp v68, v36, v12 quad_perm:[3,2,1,0] row_mask:0xf bank_mask:0xf
    v_fmac_f32_dpp v69, v37, v12 quad_perm:[3,2,1,0] row_mask:0xf bank_mask:0xf
    v_fmac_f32_dpp v70, v38, v12 quad_perm:[3,2,1,0] row_mask:0xf bank_mask:0xf
    v_fmac_f32_dpp v71, v39, v12 quad_perm:[3,2,1,0] row_mask:0xf bank_mask:0xf
    v_fmac_f32_dpp v72, v40, v12 quad_perm:[3,2,1,0] row_mask:0xf bank_mask:0xf
    v_fmac_f32_dpp v73, v41, v12 quad_perm:[3,2,1,0] row_mask:0xf bank_mask:0xf
    v_fmac_f32_dpp v74, v42, v12 quad_perm:[3,2,1,0] row_mask:0xf bank_mask:0xf
    v_fmac_f32_dpp v75, v43, v12 quad_perm:[3,2,1,0] row_mask:0xf bank_mask:0xf
    v_fmac_f32_dpp v76, v44, v12 quad_perm:[3,2,1,0] row_mask:0xf bank_mask:0xf
    v_fmac_f32_dpp v77, v45, v12 quad_perm:[3,2,1,0] row_mask:0xf bank_mask:0xf
    v_fmac_f32_dpp v78, v46, v12 quad_perm:[3,2,1,0] row_mask:0xf bank_mask:0xf
    v_fmac_f32_dpp v79, v47, v12 quad_perm:[3,2,1,0] row_mask:0xf bank_mask:0xf
    v_fmac_f32_dpp v80, v48, v12 quad_perm:[3,2,1,0] row_mask:0xf bank_mask:0xf
    v_fmac_f32_dpp v81, v49, v12 quad_perm:[3,2,1,0] row_mask:0xf bank_mask:0xf
    v_fmac_f32_dpp v82, v50, v12 quad_perm:[3,2,1,0] row_mask:0xf bank_mask:0xf
    v_fmac_f32_dpp v83, v51, v12 quad_perm:[3,2,1,0] row_mask:0xf bank_mask:0xf
    v_fmac_f32_dpp v84, v52, v12 quad_perm:[3,2,1,0] row_mask:0xf bank_mask:0xf
    v_fmac_f32_dpp v85, v53, v12 quad_perm:[3,2,1,0] row_mask:0xf bank_mask:0xf
    v_fmac_f32_dpp v86, v54, v12 quad_perm:[3,2,1,0] row_mask:0xf bank_mask:0xf
    v_fmac_f32_dpp v87, v55, v12 quad_perm:[3,2,1,0] row_mask:0xf bank_mask:0xf
    v_fmac_f32_dpp v88, v56, v12 quad_perm:[3,2,1,0] row_mask:0xf bank_mask:0xf
    v_fmac_f32_dpp v89, v57, v12 quad_perm:[3,2,1,0] row_mask:0xf bank_mask:0xf
    v_fmac_f32_dpp v90, v58, v12 quad_perm:[3,2,1,0] row_mask:0xf bank_mask:0xf
    v_fmac_f32_dpp v91, v59, v12 quad_perm:[3,2,1,0] row_mask:0xf bank_mask:0xf
    v_fmac_f32_dpp v92, v60, v12 quad_perm:[3,2,1,0] row_mask:0xf bank_mask:0xf
    v_fmac_f32_dpp v93, v61, v12 quad_perm:[3,2,1,0] row_mask:0xf bank_mask:0xf
    v_fmac_f32_dpp v94, v62, v12 quad_perm:[3,2,1,0] row_mask:0xf bank_mask:0xf
    v_fmac_f32_dpp v95, v63, v12 quad_perm:[3,2,1,0] row_mask:0xf bank_mask:0xf
K2_CK:
    v_cvt_pk_bf16_f32 v32, v32, v33
    v_cvt_pk_bf16_f32 v33, v34, v35
    v_cvt_pk_bf16_f32 v34, v36, v37
    v_cvt_pk_bf16_f32 v35, v38, v39
    v_cvt_pk_bf16_f32 v36, v40, v41
    v_cvt_pk_bf16_f32 v37, v42, v43
    v_cvt_pk_bf16_f32 v38, v44, v45
    v_cvt_pk_bf16_f32 v39, v46, v47
    v_cvt_pk_bf16_f32 v40, v48, v49
    v_cvt_pk_bf16_f32 v41, v50, v51
    v_cvt_pk_bf16_f32 v42, v52, v53
    v_cvt_pk_bf16_f32 v43, v54, v55
    v_cvt_pk_bf16_f32 v44, v56, v57
    v_cvt_pk_bf16_f32 v45, v58, v59
    v_cvt_pk_bf16_f32 v46, v60, v61
    v_cvt_pk_bf16_f32 v47, v62, v63
    v_cndmask_b32_dpp v96, v32, v96, vcc quad_perm:[0,0,0,0] row_mask:0xf bank_mask:0xf
    v_cndmask_b32_dpp v97, v33, v97, vcc quad_perm:[0,0,0,0] row_mask:0xf bank_mask:0xf
    v_cndmask_b32_dpp v98, v34, v98, vcc quad_perm:[0,0,0,0] row_mask:0xf bank_mask:0xf
    v_cndmask_b32_dpp v99, v35, v99, vcc quad_perm:[0,0,0,0] row_mask:0xf bank_mask:0xf
    v_cndmask_b32_dpp v100, v36, v100, vcc quad_perm:[0,0,0,0] row_mask:0xf bank_mask:0xf
    v_cndmask_b32_dpp v101, v37, v101, vcc quad_perm:[0,0,0,0] row_mask:0xf bank_mask:0xf
    v_cndmask_b32_dpp v102, v38, v102, vcc quad_perm:[0,0,0,0] row_mask:0xf bank_mask:0xf
    v_cndmask_b32_dpp v103, v39, v103, vcc quad_perm:[0,0,0,0] row_mask:0xf bank_mask:0xf
    v_cndmask_b32_dpp v104, v40, v104, vcc quad_perm:[0,0,0,0] row_mask:0xf bank_mask:0xf
    v_cndmask_b32_dpp v105, v41, v105, vcc quad_perm:[0,0,0,0] row_mask:0xf bank_mask:0xf
    v_cndmask_b32_dpp v106, v42, v106, vcc quad_perm:[0,0,0,0] row_mask:0xf bank_mask:0xf
    v_cndmask_b32_dpp v107, v43, v107, vcc quad_perm:[0,0,0,0] row_mask:0xf bank_mask:0xf
    v_cndmask_b32_dpp v108, v44, v108, vcc quad_perm:[0,0,0,0] row_mask:0xf bank_mask:0xf
    v_cndmask_b32_dpp v109, v45, v109, vcc quad_perm:[0,0,0,0] row_mask:0xf bank_mask:0xf
    v_cndmask_b32_dpp v110, v46, v110, vcc quad_perm:[0,0,0,0] row_mask:0xf bank_mask:0xf
    v_cndmask_b32_dpp v111, v47, v111, vcc quad_perm:[0,0,0,0] row_mask:0xf bank_mask:0xf
K2_CEND:
    s_add_u32 s23, s23, 1
    s_cmp_lt_u32 s23, 4
    s_cbranch_scc1 K2_PHASE
    v_subrev_u32 v18, s20, v9
    v_add_u32 v18, 102400, v18
    v_xor_b32 v19, 64, v18
    v_cvt_pk_bf16_f32 v64, v64, v65
    v_cvt_pk_bf16_f32 v65, v66, v67
    v_cvt_pk_bf16_f32 v66, v68, v69
    v_cvt_pk_bf16_f32 v67, v70, v71
    v_cvt_pk_bf16_f32 v68, v72, v73
    v_cvt_pk_bf16_f32 v69, v74, v75
    v_cvt_pk_bf16_f32 v70, v76, v77
    v_cvt_pk_bf16_f32 v71, v78, v79
    v_cvt_pk_bf16_f32 v72, v80, v81
    v_cvt_pk_bf16_f32 v73, v82, v83
    v_cvt_pk_bf16_f32 v74, v84, v85
    v_cvt_pk_bf16_f32 v75, v86, v87
    v_cvt_pk_bf16_f32 v76, v88, v89
    v_cvt_pk_bf16_f32 v77, v90, v91
    v_cvt_pk_bf16_f32 v78, v92, v93
    v_cvt_pk_bf16_f32 v79, v94, v95
    s_waitcnt lgkmcnt(0)
    ds_read_b64_tr_b16 v[20:21], v18 offset:0
    ds_read_b64_tr_b16 v[22:23], v18 offset:1024
    ds_read_b64_tr_b16 v[24:25], v19 offset:0
    ds_read_b64_tr_b16 v[26:27], v19 offset:1024
    ds_read_b64_tr_b16 v[28:29], v18 offset:2048
    ds_read_b64_tr_b16 v[30:31], v18 offset:3072
    s_waitcnt lgkmcnt(4)
    v_mfma_f32_32x32x16_bf16 v[32:47], v[20:23], v[112:115], 0
    ds_read_b64_tr_b16 v[20:21], v19 offset:2048
    ds_read_b64_tr_b16 v[22:23], v19 offset:3072
    s_waitcnt lgkmcnt(4)
    v_mfma_f32_32x32x16_bf16 v[48:63], v[24:27], v[112:115], 0
    ds_read_b64_tr_b16 v[24:25], v18 offset:4096
    ds_read_b64_tr_b16 v[26:27], v18 offset:5120
    s_waitcnt lgkmcnt(4)
    v_mfma_f32_32x32x16_bf16 v[32:47], v[28:31], v[116:119], v[32:47]
    ds_read_b64_tr_b16 v[28:29], v19 offset:4096
    ds_read_b64_tr_b16 v[30:31], v19 offset:5120
    s_waitcnt lgkmcnt(4)
    v_mfma_f32_32x32x16_bf16 v[48:63], v[20:23], v[116:119], v[48:63]
    ds_read_b64_tr_b16 v[20:21], v18 offset:6144
    ds_read_b64_tr_b16 v[22:23], v18 offset:7168
    s_waitcnt lgkmcnt(4)
    v_mfma_f32_32x32x16_bf16 v[32:47], v[24:27], v[120:123], v[32:47]
    ds_read_b64_tr_b16 v[24:25], v19 offset:6144
    ds_read_b64_tr_b16 v[26:27], v19 offset:7168
    s_waitcnt lgkmcnt(4)
    v_mfma_f32_32x32x16_bf16 v[48:63], v[28:31], v[120:123], v[48:63]
    ds_read_b64_tr_b16 v[28:29], v18 offset:16384
    ds_read_b64_tr_b16 v[30:31], v18 offset:17408
    s_waitcnt lgkmcnt(4)
    v_mfma_f32_32x32x16_bf16 v[32:47], v[20:23], v[124:127], v[32:47]
    ds_read_b64_tr_b16 v[20:21], v19 offset:16384
    ds_read_b64_tr_b16 v[22:23], v19 offset:17408
    s_waitcnt lgkmcnt(4)
    v_mfma_f32_32x32x16_bf16 v[48:63], v[24:27], v[124:127], v[48:63]
    ds_read_b64_tr_b16 v[24:25], v18 offset:18432
    ds_read_b64_tr_b16 v[26:27], v18 offset:19456
    s_waitcnt lgkmcnt(4)
    v_mfma_f32_32x32x16_bf16 v[80:95], v[28:31], v[112:115], 0
    ds_read_b64_tr_b16 v[28:29], v19 offset:18432
    ds_read_b64_tr_b16 v[30:31], v19 offset:19456
    s_waitcnt lgkmcnt(4)
    v_mfma_f32_32x32x16_bf16 v[2:17], v[20:23], v[112:115], 0
    ds_read_b64_tr_b16 v[20:21], v18 offset:20480
    ds_read_b64_tr_b16 v[22:23], v18 offset:21504
    s_waitcnt lgkmcnt(4)
    v_mfma_f32_32x32x16_bf16 v[80:95], v[24:27], v[116:119], v[80:95]
    ds_read_b64_tr_b16 v[24:25], v19 offset:20480
    ds_read_b64_tr_b16 v[26:27], v19 offset:21504
    s_waitcnt lgkmcnt(4)
    v_mfma_f32_32x32x16_bf16 v[2:17], v[28:31], v[116:119], v[2:17]
    ds_read_b64_tr_b16 v[28:29], v18 offset:22528
    ds_read_b64_tr_b16 v[30:31], v18 offset:23552
    s_waitcnt lgkmcnt(4)
    v_mfma_f32_32x32x16_bf16 v[80:95], v[20:23], v[120:123], v[80:95]
    ds_read_b64_tr_b16 v[20:21], v19 offset:22528
    ds_read_b64_tr_b16 v[22:23], v19 offset:23552
    s_waitcnt lgkmcnt(4)
    v_mfma_f32_32x32x16_bf16 v[2:17], v[24:27], v[120:123], v[2:17]
    ds_read_b64_tr_b16 v[24:25], v18 offset:8192
    ds_read_b64_tr_b16 v[26:27], v18 offset:9216
    s_waitcnt lgkmcnt(4)
    v_mfma_f32_32x32x16_bf16 v[80:95], v[28:31], v[124:127], v[80:95]
    ds_read_b64_tr_b16 v[28:29], v19 offset:8192
    ds_read_b64_tr_b16 v[30:31], v19 offset:9216
    s_waitcnt lgkmcnt(4)
    v_mfma_f32_32x32x16_bf16 v[2:17], v[20:23], v[124:127], v[2:17]
    ds_read_b64_tr_b16 v[20:21], v18 offset:10240
    ds_read_b64_tr_b16 v[22:23], v18 offset:11264
    s_waitcnt lgkmcnt(4)
    v_mfma_f32_32x32x16_bf16 v[32:47], v[24:27], v[64:67], v[32:47]
    ds_read_b64_tr_b16 v[24:25], v19 offset:10240
    ds_read_b64_tr_b16 v[26:27], v19 offset:11264
    s_waitcnt lgkmcnt(4)
    v_mfma_f32_32x32x16_bf16 v[48:63], v[28:31], v[64:67], v[48:63]
    ds_read_b64_tr_b16 v[28:29], v18 offset:12288
    ds_read_b64_tr_b16 v[30:31], v18 offset:13312
    s_waitcnt lgkmcnt(4)
    v_mfma_f32_32x32x16_bf16 v[32:47], v[20:23], v[68:71], v[32:47]
    ds_read_b64_tr_b16 v[20:21], v19 offset:12288
    ds_read_b64_tr_b16 v[22:23], v19 offset:13312
    s_waitcnt lgkmcnt(4)
    v_mfma_f32_32x32x16_bf16 v[48:63], v[24:27], v[68:71], v[48:63]
    ds_read_b64_tr_b16 v[24:25], v18 offset:14336
    ds_read_b64_tr_b16 v[26:27], v18 offset:15360
    s_waitcnt lgkmcnt(4)
    v_mfma_f32_32x32x16_bf16 v[32:47], v[28:31], v[72:75], v[32:47]
    ds_read_b64_tr_b16 v[28:29], v19 offset:14336
    ds_read_b64_tr_b16 v[30:31], v19 offset:15360
    s_waitcnt lgkmcnt(4)
    v_mfma_f32_32x32x16_bf16 v[48:63], v[20:23], v[72:75], v[48:63]
    ds_read_b64_tr_b16 v[20:21], v18 offset:32768
    ds_read_b64_tr_b16 v[22:23], v18 offset:33792
    s_waitcnt lgkmcnt(4)
    v_mfma_f32_32x32x16_bf16 v[32:47], v[24:27], v[76:79], v[32:47]
    ds_read_b64_tr_b16 v[24:25], v19 offset:32768
    ds_read_b64_tr_b16 v[26:27], v19 offset:33792
    s_waitcnt lgkmcnt(4)
    v_mfma_f32_32x32x16_bf16 v[48:63], v[28:31], v[76:79], v[48:63]
    ds_read_b64_tr_b16 v[28:29], v18 offset:34816
    ds_read_b64_tr_b16 v[30:31], v18 offset:35840
    s_waitcnt lgkmcnt(4)
    v_mfma_f32_32x32x16_bf16 v[80:95], v[20:23], v[64:67], v[80:95]
    ds_read_b64_tr_b16 v[20:21], v19 offset:34816
    ds_read_b64_tr_b16 v[22:23], v19 offset:35840
    s_waitcnt lgkmcnt(4)
    v_mfma_f32_32x32x16_bf16 v[2:17], v[24:27], v[64:67], v[2:17]
    ds_read_b64_tr_b16 v[24:25], v18 offset:36864
    ds_read_b64_tr_b16 v[26:27], v18 offset:37888
    s_waitcnt lgkmcnt(4)
    v_mfma_f32_32x32x16_bf16 v[80:95], v[28:31], v[68:71], v[80:95]
    ds_read_b64_tr_b16 v[28:29], v19 offset:36864
    ds_read_b64_tr_b16 v[30:31], v19 offset:37888
    s_waitcnt lgkmcnt(4)
    v_mfma_f32_32x32x16_bf16 v[2:17], v[20:23], v[68:71], v[2:17]
    ds_read_b64_tr_b16 v[20:21], v18 offset:38912
    ds_read_b64_tr_b16 v[22:23], v18 offset:39936
    s_waitcnt lgkmcnt(4)
    v_mfma_f32_32x32x16_bf16 v[80:95], v[24:27], v[72:75], v[80:95]
    ds_read_b64_tr_b16 v[24:25], v19 offset:38912
    ds_read_b64_tr_b16 v[26:27], v19 offset:39936
    s_waitcnt lgkmcnt(4)
    v_mfma_f32_32x32x16_bf16 v[2:17], v[28:31], v[72:75], v[2:17]
    ds_read_b64_tr_b16 v[28:29], v18 offset:24576
    ds_read_b64_tr_b16 v[30:31], v18 offset:25600
    s_waitcnt lgkmcnt(4)
    v_mfma_f32_32x32x16_bf16 v[80:95], v[20:23], v[76:79], v[80:95]
    ds_read_b64_tr_b16 v[20:21], v19 offset:24576
    ds_read_b64_tr_b16 v[22:23], v19 offset:25600
    s_waitcnt lgkmcnt(4)
    v_mfma_f32_32x32x16_bf16 v[2:17], v[24:27], v[76:79], v[2:17]
    ds_read_b64_tr_b16 v[24:25], v18 offset:26624
    ds_read_b64_tr_b16 v[26:27], v18 offset:27648
    s_waitcnt lgkmcnt(4)
    v_mfma_f32_32x32x16_bf16 v[80:95], v[28:31], v[96:99], v[80:95]
    ds_read_b64_tr_b16 v[28:29], v19 offset:26624
    ds_read_b64_tr_b16 v[30:31], v19 offset:27648
    s_waitcnt lgkmcnt(4)
    v_mfma_f32_32x32x16_bf16 v[2:17], v[20:23], v[96:99], v[2:17]
    ds_read_b64_tr_b16 v[20:21], v18 offset:28672
    ds_read_b64_tr_b16 v[22:23], v18 offset:29696
    s_waitcnt lgkmcnt(4)
    v_mfma_f32_32x32x16_bf16 v[80:95], v[24:27], v[100:103], v[80:95]
    ds_read_b64_tr_b16 v[24:25], v19 offset:28672
    ds_read_b64_tr_b16 v[26:27], v19 offset:29696
    s_waitcnt lgkmcnt(4)
    v_mfma_f32_32x32x16_bf16 v[2:17], v[28:31], v[100:103], v[2:17]
    ds_read_b64_tr_b16 v[28:29], v18 offset:30720
    ds_read_b64_tr_b16 v[30:31], v18 offset:31744
    s_waitcnt lgkmcnt(4)
    v_mfma_f32_32x32x16_bf16 v[80:95], v[20:23], v[104:107], v[80:95]
    ds_read_b64_tr_b16 v[20:21], v19 offset:30720
    ds_read_b64_tr_b16 v[22:23], v19 offset:31744
    s_waitcnt lgkmcnt(4)
    v_mfma_f32_32x32x16_bf16 v[2:17], v[24:27], v[104:107], v[2:17]
    s_waitcnt lgkmcnt(2)
    v_mfma_f32_32x32x16_bf16 v[80:95], v[28:31], v[108:111], v[80:95]
    s_waitcnt lgkmcnt(0)
    v_mfma_f32_32x32x16_bf16 v[2:17], v[20:23], v[108:111], v[2:17]
    v_and_b32 v112, 63, v0
    v_and_b32 v113, 3, v112
    v_cmp_eq_u32 vcc, 0, v113
    v_and_b32 v113, 31, v112
    v_lshrrev_b32 v114, 5, v112
    v_and_b32 v115, 7, v112
    v_xor_b32 v114, v114, v115
    v_lshlrev_b32 v114, 4, v114
    v_lshl_add_u32 v114, v113, 7, v114
    v_add_u32 v114, s20, v114
    v_xor_b32 v115, 32, v114
    v_xor_b32 v116, 64, v114
    v_xor_b32 v117, 96, v114
    v_lshrrev_b32 v118, 3, v112
    v_and_b32 v119, 1, v118
    v_lshlrev_b32 v119, 2, v119
    v_xor_b32 v119, v119, v112
    v_and_b32 v119, 7, v119
    v_lshlrev_b32 v119, 4, v119
    v_lshl_add_u32 v119, v118, 9, v119
    v_add_u32 v119, s20, v119
    v_xor_b32 v120, 16, v119
    v_xor_b32 v121, 32, v119
    v_xor_b32 v122, 48, v119
    v_and_b32 v123, 7, v112
    v_lshlrev_b32 v123, 4, v123
    v_lshl_add_u32 v123, v118, 9, v123
    v_cndmask_b32 v32, v80, v32, vcc
    v_cndmask_b32 v33, v81, v33, vcc
    v_cndmask_b32 v34, v82, v34, vcc
    v_cndmask_b32 v35, v83, v35, vcc
    v_cndmask_b32 v36, v84, v36, vcc
    v_cndmask_b32 v37, v85, v37, vcc
    v_cndmask_b32 v38, v86, v38, vcc
    v_cndmask_b32 v39, v87, v39, vcc
    v_cndmask_b32 v40, v88, v40, vcc
    v_cndmask_b32 v41, v89, v41, vcc
    v_cndmask_b32 v42, v90, v42, vcc
    v_cndmask_b32 v43, v91, v43, vcc
    v_cndmask_b32 v44, v92, v44, vcc
    v_cndmask_b32 v45, v93, v45, vcc
    v_cndmask_b32 v46, v94, v46, vcc
    v_cndmask_b32 v47, v95, v47, vcc
    v_cndmask_b32 v48, v2, v48, vcc
    v_cndmask_b32 v49, v3, v49, vcc
    v_cndmask_b32 v50, v4, v50, vcc
    v_cndmask_b32 v51, v5, v51, vcc
    v_cndmask_b32 v52, v6, v52, vcc
    v_cndmask_b32 v53, v7, v53, vcc
    v_cndmask_b32 v54, v8, v54, vcc
    v_cndmask_b32 v55, v9, v55, vcc
    v_cndmask_b32 v56, v10, v56, vcc
    v_cndmask_b32 v57, v11, v57, vcc
    v_cndmask_b32 v58, v12, v58, vcc
    v_cndmask_b32 v59, v13, v59, vcc
    v_cndmask_b32 v60, v14, v60, vcc
    v_cndmask_b32 v61, v15, v61, vcc
    v_cndmask_b32 v62, v16, v62, vcc
    v_cndmask_b32 v63, v17, v63, vcc
    s_cmp_eq_u32 s30, 0
    s_cbranch_scc1 K2_EPI
    s_lshl_b32 s26, s2, 4
    s_add_u32 s26, s26, s16
    s_lshl_b32 s26, s26, 13
    s_add_u32 s26, s26, 16777216
    v_lshl_add_u32 v124, v112, 7, s26
    s_cmp_eq_u32 s31, 0
    s_cbranch_scc1 K2_NOACC
    global_load_dwordx4 v[64:67], v124, s[56:57] offset:0 sc1
    global_load_dwordx4 v[68:71], v124, s[56:57] offset:16 sc1
    global_load_dwordx4 v[72:75], v124, s[56:57] offset:32 sc1
    global_load_dwordx4 v[76:79], v124, s[56:57] offset:48 sc1
    global_load_dwordx4 v[80:83], v124, s[56:57] offset:64 sc1
    global_load_dwordx4 v[84:87], v124, s[56:57] offset:80 sc1
    global_load_dwordx4 v[88:91], v124, s[56:57] offset:96 sc1
    global_load_dwordx4 v[92:95], v124, s[56:57] offset:112 sc1
    s_waitcnt vmcnt(0)
    v_add_f32 v32, v32, v64
    v_add_f32 v33, v33, v65
    v_add_f32 v34, v34, v66
    v_add_f32 v35, v35, v67
    v_add_f32 v36, v36, v68
    v_add_f32 v37, v37, v69
    v_add_f32 v38, v38, v70
    v_add_f32 v39, v39, v71
    v_add_f32 v40, v40, v72
    v_add_f32 v41, v41, v73
    v_add_f32 v42, v42, v74
    v_add_f32 v43, v43, v75
    v_add_f32 v44, v44, v76
    v_add_f32 v45, v45, v77
    v_add_f32 v46, v46, v78
    v_add_f32 v47, v47, v79
    v_add_f32 v48, v48, v80
    v_add_f32 v49, v49, v81
    v_add_f32 v50, v50, v82
    v_add_f32 v51, v51, v83
    v_add_f32 v52, v52, v84
    v_add_f32 v53, v53, v85
    v_add_f32 v54, v54, v86
    v_add_f32 v55, v55, v87
    v_add_f32 v56, v56, v88
    v_add_f32 v57, v57, v89
    v_add_f32 v58, v58, v90
    v_add_f32 v59, v59, v91
    v_add_f32 v60, v60, v92
    v_add_f32 v61, v61, v93
    v_add_f32 v62, v62, v94
    v_add_f32 v63, v63, v95
K2_NOACC:
    s_add_u32 s26, s31, 1
    s_cmp_ge_u32 s26, s32
    s_cbranch_scc1 K2_EPI
    global_store_dwordx4 v124, v[32:35], s[56:57] offset:0 sc1
    global_store_dwordx4 v124, v[36:39], s[56:57] offset:16 sc1
    global_store_dwordx4 v124, v[40:43], s[56:57] offset:32 sc1
    global_store_dwordx4 v124, v[44:47], s[56:57] offset:48 sc1
    global_store_dwordx4 v124, v[48:51], s[56:57] offset:64 sc1
    global_store_dwordx4 v124, v[52:55], s[56:57] offset:80 sc1
    global_store_dwordx4 v124, v[56:59], s[56:57] offset:96 sc1
    global_store_dwordx4 v124, v[60:63], s[56:57] offset:112 sc1
    s_branch K2_RNEXT
K2_RIDLE:
K2_RNEXT:
    s_cmp_eq_u32 s30, 0
    s_cbranch_scc1 K2_DONE
    s_add_u32 s31, s31, 1
    s_cmp_ge_u32 s31, s32
    s_cbranch_scc1 K2_DONE
    s_and_b32 s34, s31, 3
    s_lshr_b32 s33, s31, 2
    s_lshl_b32 s33, s33, 5
    s_waitcnt vmcnt(0) lgkmcnt(0)
    s_barrier
    s_branch K2_ROUND
K2_EPI:
    v_cvt_pk_bf16_f32 v32, v32, v33
    v_cvt_pk_bf16_f32 v33, v34, v35
    v_cvt_pk_bf16_f32 v34, v36, v37
    v_cvt_pk_bf16_f32 v35, v38, v39
    v_cvt_pk_bf16_f32 v36, v40, v41
    v_cvt_pk_bf16_f32 v37, v42, v43
    v_cvt_pk_bf16_f32 v38, v44, v45
    v_cvt_pk_bf16_f32 v39, v46, v47
    v_cvt_pk_bf16_f32 v40, v48, v49
    v_cvt_pk_bf16_f32 v41, v50, v51
    v_cvt_pk_bf16_f32 v42, v52, v53
    v_cvt_pk_bf16_f32 v43, v54, v55
    v_cvt_pk_bf16_f32 v44, v56, v57
    v_cvt_pk_bf16_f32 v45, v58, v59
    v_cvt_pk_bf16_f32 v46, v60, v61
    v_cvt_pk_bf16_f32 v47, v62, v63
    s_mul_i32 s26, s22, 50176
    s_mul_i32 s27, s16, 4096
    s_add_u32 s26, s26, s27
    v_permlane32_swap_b32 v32, v34
    v_permlane32_swap_b32 v33, v35
    ds_write_b128 v114, v[32:35]
    v_permlane32_swap_b32 v36, v38
    v_permlane32_swap_b32 v37, v39
    ds_write_b128 v115, v[36:39]
    v_permlane32_swap_b32 v40, v42
    v_permlane32_swap_b32 v41, v43
    ds_write_b128 v116, v[40:43]
    v_permlane32_swap_b32 v44, v46
    v_permlane32_swap_b32 v45, v47
    ds_write_b128 v117, v[44:47]
    s_mov_b32 s27, 0xbfb8aa3b
    s_mov_b32 s28, 0xffff0000
    s_cmp_lt_u32 s16, 12
    s_cbranch_scc1 K2_FULL
    s_mov_b64 exec, 0xffff
K2_FULL:
    s_waitcnt lgkmcnt(0)
    ds_read_b128 v[64:67], v119 offset:0
    ds_read_b128 v[68:71], v120 offset:128
    ds_read_b128 v[72:75], v121 offset:256
    ds_read_b128 v[76:79], v122 offset:384
    s_waitcnt lgkmcnt(3)
    buffer_store_dwordx4 v[64:67], v123, s[12:15], s26 offen sc1
    v_lshlrev_b32 v80, 16, v64
    v_and_b32 v81, s28, v64
    v_lshlrev_b32 v82, 16, v65
    v_and_b32 v83, s28, v65
    v_lshlrev_b32 v84, 16, v66
    v_and_b32 v85, s28, v66
    v_lshlrev_b32 v86, 16, v67
    v_and_b32 v87, s28, v67
    v_mul_f32 v80, s27, v80
    v_mul_f32 v81, s27, v81
    v_mul_f32 v82, s27, v82
    v_mul_f32 v83, s27, v83
    v_mul_f32 v84, s27, v84
    v_mul_f32 v85, s27, v85
    v_mul_f32 v86, s27, v86
    v_mul_f32 v87, s27, v87
    v_exp_f32 v80, v80
    v_exp_f32 v81, v81
    v_exp_f32 v82, v82
    v_exp_f32 v83, v83
    v_exp_f32 v84, v84
    v_exp_f32 v85, v85
    v_exp_f32 v86, v86
    v_exp_f32 v87, v87
    v_add_f32 v80, 1.0, v80
    v_add_f32 v81, 1.0, v81
    v_add_f32 v82, 1.0, v82
    v_add_f32 v83, 1.0, v83
    v_add_f32 v84, 1.0, v84
    v_add_f32 v85, 1.0, v85
    v_add_f32 v86, 1.0, v86
    v_add_f32 v87, 1.0, v87
    v_rcp_f32 v80, v80
    v_rcp_f32 v81, v81
    v_rcp_f32 v82, v82
    v_rcp_f32 v83, v83
    v_rcp_f32 v84, v84
    v_rcp_f32 v85, v85
    v_rcp_f32 v86, v86
    v_rcp_f32 v87, v87
    s_waitcnt lgkmcnt(2)
    v_lshlrev_b32 v88, 16, v68
    v_and_b32 v89, s28, v68
    v_lshlrev_b32 v90, 16, v69
    v_and_b32 v91, s28, v69
    v_lshlrev_b32 v92, 16, v70
    v_and_b32 v93, s28, v70
    v_lshlrev_b32 v94, 16, v71
    v_and_b32 v95, s28, v71
    v_pk_mul_f32 v[88:89], v[88:89], v[80:81]
    v_pk_mul_f32 v[90:91], v[90:91], v[82:83]
    v_pk_mul_f32 v[92:93], v[92:93], v[84:85]
    v_pk_mul_f32 v[94:95], v[94:95], v[86:87]
    v_cvt_pk_bf16_f32 v68, v88, v89
    v_cvt_pk_bf16_f32 v69, v90, v91
    v_cvt_pk_bf16_f32 v70, v92, v93
    v_cvt_pk_bf16_f32 v71, v94, v95
    buffer_store_dwordx4 v[68:71], v123, s[12:15], s26 offen offset:128 sc1
    s_waitcnt lgkmcnt(1)
    v_lshlrev_b32 v88, 16, v72
    v_and_b32 v89, s28, v72
    v_lshlrev_b32 v90, 16, v73
    v_and_b32 v91, s28, v73
    v_lshlrev_b32 v92, 16, v74
    v_and_b32 v93, s28, v74
    v_lshlrev_b32 v94, 16, v75
    v_and_b32 v95, s28, v75
    v_pk_mul_f32 v[88:89], v[88:89], v[80:81]
    v_pk_mul_f32 v[90:91], v[90:91], v[82:83]
    v_pk_mul_f32 v[92:93], v[92:93], v[84:85]
    v_pk_mul_f32 v[94:95], v[94:95], v[86:87]
    v_cvt_pk_bf16_f32 v72, v88, v89
    v_cvt_pk_bf16_f32 v73, v90, v91
    v_cvt_pk_bf16_f32 v74, v92, v93
    v_cvt_pk_bf16_f32 v75, v94, v95
    buffer_store_dwordx4 v[72:75], v123, s[12:15], s26 offen offset:256 sc1
    s_waitcnt lgkmcnt(0)
    v_lshlrev_b32 v88, 16, v76
    v_and_b32 v89, s28, v76
    v_lshlrev_b32 v90, 16, v77
    v_and_b32 v91, s28, v77
    v_lshlrev_b32 v92, 16, v78
    v_and_b32 v93, s28, v78
    v_lshlrev_b32 v94, 16, v79
    v_and_b32 v95, s28, v79
    v_pk_mul_f32 v[88:89], v[88:89], v[80:81]
    v_pk_mul_f32 v[90:91], v[90:91], v[82:83]
    v_pk_mul_f32 v[92:93], v[92:93], v[84:85]
    v_pk_mul_f32 v[94:95], v[94:95], v[86:87]
    v_cvt_pk_bf16_f32 v76, v88, v89
    v_cvt_pk_bf16_f32 v77, v90, v91
    v_cvt_pk_bf16_f32 v78, v92, v93
    v_cvt_pk_bf16_f32 v79, v94, v95
    buffer_store_dwordx4 v[76:79], v123, s[12:15], s26 offen offset:384 sc1
K2_DONE:
K2_END:
    s_endpgm
.section .rodata,"a"
.p2align 6

.amdhsa_kernel standalone__tensor_product_equiv_equiformer__graph_kernel
  .amdhsa_next_free_vgpr 128
  .amdhsa_next_free_sgpr 72
  .amdhsa_accum_offset 128
  .amdhsa_group_segment_fixed_size 0
  .amdhsa_kernarg_size 96
  .amdhsa_user_sgpr_count 2
  .amdhsa_user_sgpr_kernarg_segment_ptr 1
  .amdhsa_system_sgpr_workgroup_id_x 1
  .amdhsa_float_denorm_mode_32 3
.end_amdhsa_kernel
```
